```python
import torch

def _softmax(x, axis=-1):
    return torch.softmax(x, dim=axis)
def _gelu(x):
    return torch.nn.functional.gelu(x, approximate="tanh")
def _silu(x):
    return torch.nn.functional.silu(x)
def _sigmoid(x):
    return torch.sigmoid(x)
def _layernorm(x, axis=-1, eps=1e-5):
    m = x.mean(dim=axis, keepdim=True)
    v = x.var(dim=axis, keepdim=True, unbiased=False)
    return (x - m) / torch.sqrt(v + eps)
def _scatter_add(tgt, idx, src, axis=0):
    return tgt.clone().index_add_(axis, idx, src)
def _segment_sum(src, seg, n):
    out = torch.zeros((n,) + src.shape[1:], dtype=src.dtype)
    return out.index_add_(0, seg, src)
def _pad(x, pw):
    flat = tuple(v for pair in reversed(pw) for v in pair)
    return torch.nn.functional.pad(x, flat)

kernel_name = 'gated_mix__grouped_kv_mqa__spectral_fnet__prompt'

def setup_inputs():

    _w = (lambda a: (lambda t: t.to(torch.bfloat16) if t.is_floating_point() else t)(torch.as_tensor(a)))
    def _A_setup():
        B, S, D, H = 1, 2048, 640, 32
        Dh = D // H
        return {
            "x": _w((lambda *s: torch.randn(*s, dtype=torch.bfloat16) * 0.05)(B, S, D)),
            "wq": _w((lambda *s: torch.randn(*s, dtype=torch.bfloat16) * 1.6)(D, H * Dh)),
            "wk": _w((lambda *s: torch.randn(*s, dtype=torch.bfloat16) * 1.6)(D, Dh)),
            "wv": _w((lambda *s: torch.randn(*s, dtype=torch.bfloat16) * 1.6)(D, Dh)),
            "wo": _w((lambda *s: torch.randn(*s, dtype=torch.bfloat16) * 1.6)(H * Dh, D)),
        }
    _A_in = _A_setup()

    def _B_setup():
        B, S, D = 1, 2048, 640
        ns = torch.arange(S)[:, None] * torch.arange(S)[None, :]
        nd = torch.arange(D)[:, None] * torch.arange(D)[None, :]
        Ws_re = torch.cos(-2.0 * torch.pi * ns / S).to(float)
        Ws_im = torch.sin(-2.0 * torch.pi * ns / S).to(float)
        Wd_re = torch.cos(-2.0 * torch.pi * nd / D).to(float)
        Wd_im = torch.sin(-2.0 * torch.pi * nd / D).to(float)
        return {
            "x": _w((lambda *s: torch.randn(*s, dtype=torch.bfloat16) * 0.05)(B, S, D)),
            "dft_seq_re": _w(Ws_re),
            "dft_seq_im": _w(Ws_im),
            "dft_hid_re": _w(Wd_re),
            "dft_hid_im": _w(Wd_im),
        }
    _B_in = _B_setup()

    return {
        "A_x": _A_in["x"],
        "A_wq": _A_in["wq"],
        "A_wk": _A_in["wk"],
        "A_wv": _A_in["wv"],
        "A_wo": _A_in["wo"],
        "B_x": _B_in["x"],
        "B_dft_seq_re": _B_in["dft_seq_re"],
        "B_dft_seq_im": _B_in["dft_seq_im"],
        "B_dft_hid_re": _B_in["dft_hid_re"],
        "B_dft_hid_im": _B_in["dft_hid_im"],
        "gate_w": _w((lambda *s: torch.randn(*s, dtype=torch.bfloat16) * 0.05)(640) * 16.0),
    }

def reference(A_x, A_wq, A_wk, A_wv, A_wo, B_x, B_dft_seq_re, B_dft_seq_im, B_dft_hid_re, B_dft_hid_im, gate_w):
    def _A_ref(x, wq, wk, wv, wo):
        B, S, D = x.shape
        H = 32
        Dh = D // H
        q = (lambda x, *d: x.permute(*d))((x @ wq).reshape(B, S, H, Dh), 0, 2, 1, 3)
        k = x @ wk
        v = x @ wv
        scores = torch.einsum("bhqd,bkd->bhqk", q, k) * (Dh ** -0.5)
        p = _softmax(scores, axis=-1)
        o = torch.einsum("bhqk,bkd->bhqd", p, v)
        return (lambda x, *d: x.permute(*d))(o, 0, 2, 1, 3).reshape(B, S, H * Dh) @ wo

    def _B_ref(x, dft_seq_re, dft_seq_im, dft_hid_re, dft_hid_im):
        a = torch.einsum("bsd,ed->bse", x, dft_hid_re)
        b = torch.einsum("bsd,ed->bse", x, dft_hid_im)
        y = torch.einsum("ts,bse->bte", dft_seq_re, a) - torch.einsum("ts,bse->bte", dft_seq_im, b)
        return y

    x = A_x
    g = _sigmoid((x * gate_w).sum(-1, keepdims=True))
    a = _A_ref(x, A_wq, A_wk, A_wv, A_wo)
    b = _B_ref(x, B_dft_seq_re, B_dft_seq_im, B_dft_hid_re, B_dft_hid_im)
    return g * a + (1 - g) * b
```

```asm
; @launch grid=(256,1,1) block=(512,1,1) lds=163840
.amdgcn_target "amdgcn-amd-amdhsa--gfx950"
.text
.globl gated_mix__grouped_kv_mqa__spectral_fnet__prompt_kernel
.p2align 8
.type gated_mix__grouped_kv_mqa__spectral_fnet__prompt_kernel,@function
gated_mix__grouped_kv_mqa__spectral_fnet__prompt_kernel:
    s_cmp_ge_u32 s2, 256
    s_cbranch_scc1 f_end
    s_load_dwordx16 s[8:23], s[0:1], 0
    s_load_dwordx8 s[24:31], s[0:1], 64
    s_load_dwordx4 s[32:35], s[0:1], 96
    s_getpc_b64 s[52:53]
p_pc:
    v_lshlrev_b32 v2, 2, v0
    s_bfe_u32 s3, s2, 0x50003
    s_lshl_b32 s3, s3, 11
    v_mov_b32 v3, 0
    v_add_u32 v2, s3, v2
    v_min_u32 v2, f_end-p_pc-4, v2
    v_lshl_add_u64 v[2:3], v[2:3], 0, s[52:53]
    global_load_dword v253, v[2:3], off
    v_lshrrev_b32 v1, 6, v0
    v_and_b32 v0, 63, v0
    s_and_b32 s3, s2, 7
    s_lshr_b32 s4, s2, 3
    v_readfirstlane_b32 s92, v1
    s_lshl_b32 s3, s3, 2
    s_lshr_b32 s5, s4, 3
    s_add_u32 s93, s3, s5
    s_and_b32 s94, s4, 7
    s_mul_i32 s95, s93, 1280
    s_lshr_b32 s96, s92, 2
    s_and_b32 s97, s92, 3
    v_lshrrev_b32 v4, 4, v0
    v_lshlrev_b32 v5, 4, v0
    v_lshrrev_b32 v6, 3, v0
    v_and_b32 v7, 7, v0
    s_and_b32 s3, s93, 3
    s_mul_i32 s3, s3, 5
    s_add_u32 s3, s3, 1
    s_lshr_b32 s6, s3, 1
    s_add_u32 s6, s6, s94
    s_sub_u32 s3, s6, 10
    s_cselect_b32 s6, s6, s3
    s_bfe_u32 s3, s94, 0x10001
    s_mul_i32 s3, s3, 40960
    s_add_u32 s3, s3, s95
    s_and_b32 s4, s94, 1
    s_lshl_b32 s4, s4, 1
    s_and_b32 s5, s92, 1
    s_add_u32 s4, s4, s5
    s_mul_i32 s4, s4, 655360
    s_add_u32 s3, s3, s4
    s_lshl_b32 s99, s5, 10
    s_lshl_b32 s5, s5, 6
    v_xor_b32 v234, v7, v4
    v_mul_u32_u24 v235, 81920, v6
    v_lshl_add_u32 v232, v234, 4, v235
    v_xor_b32 v232, s5, v232
    v_add_u32 v232, s3, v232
    s_lshr_b32 s98, s92, 1
    s_mul_i32 s98, s98, 5
    s_lshl_b32 s3, s98, 13
    s_add_u32 s99, s99, s3
    s_add_u32 s98, s98, s6
    s_sub_u32 s3, s98, 10
    s_cselect_b32 s98, s98, s3
    s_lshl_b32 s98, s98, 7
    s_mul_i32 s100, s97, 6144
    s_bitcmp1_b32 s94, 0
    s_cselect_b32 s3, 3072, 0
    s_cselect_b32 s4, 0, 3072
    s_add_u32 s101, s100, s4
    s_add_u32 s100, s100, s3
    v_lshlrev_b32 v239, 8, v0
    v_add_u32 v239, 294912, v239
    v_mov_b32 v240, 0
    v_mov_b32 v241, 1
    s_lshl_b32 s7, s2, 3
    s_add_u32 s7, s7, s92
    v_and_b32 v1, 31, v0
    v_lshrrev_b32 v2, 5, v0
    v_and_b32 v3, 15, v0
    s_mul_i32 s3, s92, 6
    v_add_u32 v236, s3, v6
    v_bfe_u32 v237, v236, 1, 3
    v_xor_b32 v237, v237, v7
    s_andn2_b32 s3, 3, s94
    s_lshl_b32 s3, s3, 4
    v_xor_b32 v236, s3, v236
    v_and_b32 v238, 31, v236
    v_bfe_u32 v236, v236, 5, 1
    v_lshl_add_u32 v236, v238, 1, v236
    v_mul_u32_u24 v236, 40960, v236
    v_lshl_add_u32 v236, v237, 4, v236
    v_add_u32 v204, s95, v236
    s_mul_i32 s3, s94, 160
    s_mul_i32 s4, s92, 10240
    s_add_u32 s4, s4, s3
    v_mul_u32_u24 v237, 5462, v0
    v_lshrrev_b32 v237, 16, v237
    v_mul_u32_u24 v237, 1088, v237
    v_add3_u32 v205, s4, v237, v5
    s_waitcnt lgkmcnt(0)
    s_mov_b32 s36, s8
    s_and_b32 s37, s9, 0xffff
    s_mov_b32 s38, 2621440
    s_mov_b32 s39, 0x00020000
    s_mov_b32 s64, s34
    s_and_b32 s65, s35, 0xffff
    s_mov_b32 s66, 16777216
    s_mov_b32 s67, 0x00020000
    s_cmp_lg_u32 s7, 7
    s_cbranch_scc1 p_noinit
    buffer_store_dword v240, v239, s[64:67], 0 offen sc1
p_noinit:
    s_cmp_lt_u32 s94, 4
    s_cselect_b32 s4, s12, s14
    s_cselect_b32 s5, s13, s15
    s_mov_b32 s44, s4
    s_and_b32 s45, s5, 0xffff
    s_mov_b32 s46, 25600
    s_mov_b32 s47, 0x00020000
    s_cmp_lt_u32 s92, 4
    s_cbranch_scc0 p_pos2b
    s_add_u32 m0, s99, 6144
    s_nop 0
    buffer_load_dwordx4 v232, s[36:39], s98 offen lds
    s_add_u32 s98, s98, 128
    s_cmp_eq_u32 s98, 1280
    s_cselect_b32 s98, 0, s98
    s_add_u32 m0, s99, 14336
    s_nop 0
    buffer_load_dwordx4 v232, s[36:39], s98 offen lds
    s_add_u32 s98, s98, 128
    s_cmp_eq_u32 s98, 1280
    s_cselect_b32 s98, 0, s98
    s_add_u32 m0, s99, 22528
    s_nop 0
    buffer_load_dwordx4 v232, s[36:39], s98 offen lds
    s_add_u32 s98, s98, 128
    s_cmp_eq_u32 s98, 1280
    s_cselect_b32 s98, 0, s98
    s_add_u32 m0, s99, 30720
    s_nop 0
    buffer_load_dwordx4 v232, s[36:39], s98 offen lds
    s_add_u32 s98, s98, 128
    s_cmp_eq_u32 s98, 1280
    s_cselect_b32 s98, 0, s98
    s_add_u32 m0, s99, 38912
    s_nop 0
    buffer_load_dwordx4 v232, s[36:39], s98 offen lds
    s_cmp_eq_u32 s92, 0
    s_cbranch_scc0 p_pos2c
    s_mov_b32 m0, 143360
    s_movk_i32 s98, 24576
    buffer_load_dwordx4 v5, s[44:47], s98 offen lds
    s_branch p_pos2e
p_pos2c:
    s_mov_b32 s48, s28
    s_and_b32 s49, s29, 0xffff
    s_mov_b32 s50, 1280
    s_mov_b32 s51, 0x00020000
    s_cmp_eq_u32 s92, 1
    s_cselect_b32 s98, 0, 1024
    s_add_u32 m0, s98, 152576
    s_nop 0
    buffer_load_dwordx4 v5, s[48:51], s98 offen lds
    s_branch p_pos2e
p_pos2b:
    s_add_u32 m0, s100, 118784
    s_nop 0
    buffer_load_dwordx4 v5, s[44:47], s100 offen offset:0 lds
    buffer_load_dwordx4 v5, s[44:47], s100 offen offset:1024 lds
    buffer_load_dwordx4 v5, s[44:47], s100 offen offset:2048 lds
p_pos2e:
    s_mov_b32 s40, s10
    s_and_b32 s41, s11, 0xffff
    s_mov_b32 s42, 819200
    s_mov_b32 s43, 0x00020000
    s_mov_b32 s68, s32
    s_and_b32 s69, s33, 0xffff
    s_mov_b32 s70, 256
    s_mov_b32 s71, 0x00020000
    s_mov_b32 s72, s16
    s_and_b32 s73, s17, 0xffff
    s_mov_b32 s74, 819200
    s_mov_b32 s75, 0x00020000
    s_mov_b32 s56, s24
    s_and_b32 s57, s25, 0xffff
    s_mov_b32 s58, 819200
    s_mov_b32 s59, 0x00020000
    s_mov_b32 s60, s26
    s_and_b32 s61, s27, 0xffff
    s_mov_b32 s62, 819200
    s_mov_b32 s63, 0x00020000
    s_and_b32 s34, s92, 1
    s_lshl_b32 s35, s96, 1
    s_add_u32 s34, s34, s35
    s_lshr_b32 s35, s97, 1
    s_mov_b32 s8, -1
    s_movk_i32 s9, 0xff
    s_mov_b32 s10, -1
    s_mov_b32 s11, 0xffff
    s_mov_b32 s12, -1
    s_mov_b32 s13, 0x3ffff
    s_lshl_b32 s14, s92, 10
    s_mul_i32 s15, s92, 768
    s_mul_i32 s20, s92, 1536
    s_mul_i32 s21, s92, 800
    s_mov_b32 s28, 0xff3ff3ff
    s_mov_b32 s29, 0x3ff3
    s_mov_b32 s23, s6
    s_cmp_lg_u32 s7, 7
    s_cbranch_scc1 p_noinit2
    s_waitcnt vmcnt(3)
    s_mov_b64 exec, 1
    buffer_store_dword v241, v240, s[68:71], 0 offen sc1
    s_mov_b64 exec, -1
p_noinit2:
    s_and_b32 s98, s92, 1
    s_lshr_b32 s99, s92, 1
    s_and_b32 s3, s99, 1
    s_lshl_b32 s3, s3, 2
    v_add_u32 v232, s3, v4
    v_lshrrev_b32 v233, 1, v3
    v_xor_b32 v232, v232, v233
    v_lshlrev_b32 v232, 4, v232
    v_lshl_add_u32 v232, v3, 7, v232
    v_add_u32 v232, 6144, v232
    s_lshr_b32 s3, s99, 1
    s_sub_u32 s3, s3, s23
    s_add_u32 s4, s3, 10
    s_sub_u32 s5, s4, 10
    s_cselect_b32 s4, s4, s5
    v_lshl_add_u32 v96, s4, 13, v232
    s_add_u32 s4, s3, 12
    s_sub_u32 s5, s4, 10
    s_cselect_b32 s4, s4, s5
    v_lshl_add_u32 v97, s4, 13, v232
    s_add_u32 s4, s3, 14
    s_sub_u32 s5, s4, 10
    s_cselect_b32 s4, s4, s5
    v_lshl_add_u32 v98, s4, 13, v232
    s_add_u32 s4, s3, 16
    s_sub_u32 s5, s4, 10
    s_cselect_b32 s4, s4, s5
    v_lshl_add_u32 v99, s4, 13, v232
    s_add_u32 s4, s3, 18
    s_sub_u32 s5, s4, 10
    s_cselect_b32 s4, s4, s5
    v_lshl_add_u32 v100, s4, 13, v232
    v_bfe_u32 v232, v0, 2, 2
    v_lshl_add_u32 v232, v4, 3, v232
    v_mul_u32_u24 v232, 40, v232
    v_and_b32 v233, 3, v0
    v_lshl_add_u32 v232, v233, 3, v232
    s_mul_i32 s3, s99, 1280
    s_lshl_b32 s4, s98, 5
    s_add_u32 s3, s3, s4
    s_add_u32 s3, s3, 118784
    v_add_u32 v61, s3, v232
    s_lshl_b32 s3, s99, 6
    s_add_u32 s3, s3, 152576
    v_lshlrev_b32 v62, 4, v4
    v_add_u32 v62, s3, v62
    s_add_u32 s3, s14, 144384
    v_add_u32 v63, s3, v5
    s_lshl_b32 s3, s99, 8
    s_add_u32 s3, s3, 155648
    v_lshl_add_u32 v8, v0, 2, s3
    s_cmp_lt_u32 s92, 4
    s_cbranch_scc1 p_h2
    s_add_u32 m0, s101, 118784
    s_nop 0
    buffer_load_dwordx4 v5, s[44:47], s101 offen offset:0 lds
    buffer_load_dwordx4 v5, s[44:47], s101 offen offset:1024 lds
    buffer_load_dwordx4 v5, s[44:47], s101 offen offset:2048 lds
p_h2:
    s_bitcmp1_b32 s92, 0
    s_cselect_b32 s3, 2, 3
    s_cmp_eq_u32 s92, 2
    s_cselect_b32 s3, 1, s3
    s_cmp_lt_u32 s94, 4
    s_cselect_b32 s3, s3, 3
    s_cmp_eq_u32 s92, 0
    s_cselect_b32 s19, 0, s3
    s_mul_i32 s98, s93, 6144
    s_bfe_u32 s3, s94, 0x10001
    s_mul_i32 s3, s3, 3072
    s_add_u32 s98, s98, s3
    s_and_b32 s99, s94, 1
    v_mov_b32 v240, 0x40000000
    s_cmp_lt_u32 s94, 4
    s_cbranch_scc0 kva_v
    v_lshlrev_b32 v232, 4, v3
    v_add_u32 v232, 1024, v232
    v_cmp_gt_u32 vcc, 32, v0
    s_nop 1
    v_cndmask_b32 v232, v232, v5, vcc
    v_add_u32 v9, 144384, v232
    s_lshl_b32 s3, s99, 8
    s_add_u32 s3, s3, s98
    v_lshlrev_b32 v234, 9, v4
    v_lshl_add_u32 v234, v3, 4, v234
    v_add_u32 v234, s3, v234
    v_cndmask_b32 v10, v240, v234, vcc
    s_lshl_b32 s3, s99, 7
    s_add_u32 s3, s3, s98
    s_sub_u32 s3, s3, 512
    v_lshl_add_u32 v235, v3, 3, s3
    v_lshl_add_u32 v235, v4, 8, v235
    v_cndmask_b32 v11, v235, v240, vcc
    s_lshl_b32 s3, s93, 2
    s_add_u32 s3, s3, s94
    s_lshl_b32 s3, s3, 6
    v_lshl_add_u32 v12, v3, 2, s3
    s_branch kva_j
kva_v:
    v_cmp_lt_u32 vcc, 23, v0
    s_nop 1
    v_cndmask_b32 v233, 0, 1, vcc
    v_mul_u32_u24 v234, 24, v233
    v_sub_u32 v234, v0, v234
    v_min_u32 v12, 23, v234
    v_lshrrev_b32 v232, 4, v12
    v_lshlrev_b32 v232, 10, v232
    v_and_b32 v235, 15, v12
    v_lshl_add_u32 v235, v233, 4, v235
    v_lshl_add_u32 v232, v235, 4, v232
    v_add_u32 v9, 144384, v232
    s_mul_i32 s3, s99, 768
    s_add_u32 s3, s3, s98
    v_add_u32 v10, s3, v5
    v_mov_b32 v236, 0x3f803f80
    v_cmp_eq_u32 vcc, 20, v12
    s_nop 1
    v_cndmask_b32 v11, 0, v236, vcc
kva_j:
    v_mov_b32 v13, 0
    v_bfe_u32 v232, v0, 1, 3
    s_andn2_b32 s3, 3, s94
    s_lshl_b32 s4, s96, 1
    s_xor_b32 s3, s3, s4
    s_lshl_b32 s3, s3, 11
    v_lshlrev_b32 v235, 7, v1
    v_xor_b32 v235, s3, v235
    v_add_u32 v233, 0, v2
    v_xor_b32 v233, v233, v232
    v_lshl_add_u32 v216, v233, 4, v235
    v_add_u32 v184, 0x10000, v216
    v_add_u32 v233, 2, v2
    v_xor_b32 v233, v233, v232
    v_lshl_add_u32 v217, v233, 4, v235
    v_add_u32 v185, 0x10000, v217
    v_add_u32 v233, 4, v2
    v_xor_b32 v233, v233, v232
    v_lshl_add_u32 v218, v233, 4, v235
    v_add_u32 v186, 0x10000, v218
    v_add_u32 v233, 6, v2
    v_xor_b32 v233, v233, v232
    v_lshl_add_u32 v219, v233, 4, v235
    v_add_u32 v187, 0x10000, v219
    v_bfe_u32 v232, v0, 2, 2
    v_lshl_add_u32 v232, v2, 3, v232
    v_mul_u32_u24 v232, 192, v232
    v_bfe_u32 v233, v0, 4, 1
    v_lshl_add_u32 v232, v233, 5, v232
    v_and_b32 v233, 3, v0
    v_lshl_add_u32 v232, v233, 3, v232
    s_mul_i32 s3, s97, 40
    s_add_u32 s3, s3, 81920
    v_add_u32 v192, s3, v232
    v_add_u32 v193, 36864, v192
    s_mul_i32 s3, s92, 1536
    s_add_u32 s3, s3, 106496
    s_xor_b32 s4, s92, 4
    s_mul_i32 s4, s4, 1536
    s_add_u32 s4, s4, 106496
    v_add_u32 v188, s3, v5
    v_lshl_add_u32 v189, v0, 3, s3
    v_add_u32 v190, s4, v5
    v_lshl_add_u32 v191, v0, 3, s4
    s_lshl_b32 s3, s96, 5
    s_add_u32 s3, s3, s93
    s_and_b32 s4, s97, 1
    s_lshl_b32 s4, s4, 10
    s_add_u32 s3, s3, s4
    v_lshl_add_u32 v194, v3, 6, s3
    v_cvt_f32_u32 v194, v194
    v_mul_f32 v194, 0x3a000000, v194
    v_cvt_f32_u32 v195, v4
    s_mul_i32 s3, s35, 0x3e800000
    v_fma_f32 v195, v195, v194, s3
    v_mov_b32 v196, v195
    v_fmamk_f32 v197, v194, 0x42000000, v195
    v_fmamk_f32 v198, v194, 0x40800000, v195
    v_fmamk_f32 v199, v194, 0x42100000, v195
    v_fmamk_f32 v200, v194, 0x41000000, v195
    v_fmamk_f32 v201, v194, 0x42200000, v195
    v_fmamk_f32 v202, v194, 0x41400000, v195
    v_fmamk_f32 v203, v194, 0x42300000, v195
    v_cos_f32 v196, v196
    v_cos_f32 v197, v197
    v_cos_f32 v198, v198
    v_cvt_pk_bf16_f32 v136, v196, v197
    v_cos_f32 v199, v199
    v_cos_f32 v200, v200
    v_cvt_pk_bf16_f32 v137, v198, v199
    v_cos_f32 v201, v201
    v_cos_f32 v202, v202
    v_cvt_pk_bf16_f32 v138, v200, v201
    v_cos_f32 v203, v203
    s_nop 0
    v_cvt_pk_bf16_f32 v139, v202, v203
    s_add_u32 s16, s23, 0
    s_sub_u32 s100, s16, 10
    s_cselect_b32 s16, s16, s100
    s_mul_i32 s100, s16, 81920
    s_lshl_b32 s16, s16, 7
    s_mov_b64 exec, s[28:29]
    s_add_u32 m0, s20, 81920
    s_nop 0
    buffer_load_dwordx4 v205, s[40:43], s100 offen lds
    s_add_u32 s100, s100, 5120
    s_add_u32 m0, s20, 82688
    s_nop 0
    buffer_load_dwordx4 v205, s[40:43], s100 offen lds
    s_add_u32 m0, s15, 0
    s_mov_b64 exec, s[10:11]
    buffer_load_dwordx4 v204, s[36:39], s16 offen lds
    s_mov_b64 exec, -1
    v_add_u32 v206, s15, v5
    v_lshlrev_b32 v226, 8, v3
    v_add_u32 v226, 294912, v226
    v_mul_u32_u24 v232, 6554, v0
    v_lshrrev_b32 v232, 16, v232
    v_mul_u32_u24 v234, 10, v232
    v_sub_u32 v233, v0, v234
    v_mul_u32_u24 v232, 1280, v232
    v_lshl_add_u32 v232, v233, 4, v232
    s_mul_i32 s3, s94, 160
    s_mul_i32 s4, s92, 6400
    s_add_u32 s4, s4, s3
    v_add_u32 v209, s4, v232
    v_lshrrev_b32 v235, 1, v3
    v_bfe_u32 v234, v0, 4, 1
    v_mul_u32_u24 v234, 48, v234
    v_add_u32 v234, v234, v3
    s_lshl_b32 s3, s97, 11
    s_add_u32 s3, s3, 81920
    v_lshl_add_u32 v234, v234, 7, s3
    v_add_u32 v233, 0, v2
    v_xor_b32 v233, v233, v235
    v_lshl_add_u32 v220, v233, 4, v234
    v_xor_b32 v228, 0x1000, v216
    v_add_u32 v233, 2, v2
    v_xor_b32 v233, v233, v235
    v_lshl_add_u32 v221, v233, 4, v234
    v_xor_b32 v229, 0x1000, v217
    v_add_u32 v233, 4, v2
    v_xor_b32 v233, v233, v235
    v_lshl_add_u32 v222, v233, 4, v234
    v_xor_b32 v230, 0x1000, v218
    v_add_u32 v233, 6, v2
    v_xor_b32 v233, v233, v235
    v_lshl_add_u32 v223, v233, 4, v234
    v_xor_b32 v231, 0x1000, v219
    s_mul_i32 s3, s92, 6
    v_add_u32 v232, s3, v6
    v_bfe_u32 v233, v232, 1, 3
    v_xor_b32 v233, v233, v7
    s_mul_i32 s3, s94, 48
    v_add_u32 v232, s3, v232
    v_mul_u32_u24 v232, 1280, v232
    v_lshl_add_u32 v208, v233, 4, v232
    s_mul_i32 s3, s96, 3072
    s_add_u32 s3, s3, 122880
    v_add_u32 v213, s3, v5
    v_lshl_add_u32 v214, v0, 3, s3
    v_min_u32 v232, 23, v1
    v_mul_u32_u24 v233, 24, v2
    v_add_u32 v232, v232, v233
    v_lshl_add_u32 v215, v232, 4, s3
    s_mov_b32 s3, 122880
    v_add_u32 v211, s3, v5
    v_lshl_add_u32 v212, v0, 3, s3
    v_lshl_add_u32 v7, v232, 4, s3
    s_sub_u32 s4, 32, s93
    s_and_b32 s4, s4, 31
    s_mul_i32 s5, s94, 320
    s_sub_u32 s6, 2244, s5
    s_cmp_lt_u32 s94, 4
    s_cselect_b32 s3, s93, s4
    s_cselect_b32 s5, s5, s6
    s_cselect_b32 s6, 4, -4
    s_cselect_b32 s4, 0, 316
    s_lshl_b32 s27, s6, 4
    s_lshl_b32 s3, s3, 3
    s_add_u32 s3, s3, s92
    s_mul_i32 s3, s3, 12288
    s_add_u32 s3, s3, s5
    s_add_u32 s3, s3, 1048576
    v_mul_u32_u24 v232, 3277, v0
    v_lshrrev_b32 v232, 16, v232
    v_mul_u32_u24 v232, 1216, v232
    v_add3_u32 v210, v232, v5, s3
    s_mul_i32 s22, s92, 2560
    s_lshl_b32 s3, s34, 2
    s_add_u32 s3, s3, 132160
    v_mov_b32 v250, s3
    s_mul_i32 s3, s35, 10240
    s_add_u32 s3, s3, s4
    s_add_u32 s3, s3, 102400
    v_mul_lo_u32 v232, v3, s6
    v_mul_u32_u24 v233, 320, v4
    v_add3_u32 v224, v232, v233, s3
    s_mov_b32 s18, 0
    s_lshl_b32 s3, s93, 1
    s_add_u32 s3, s3, s96
    s_mul_i32 s3, s3, 40960
    s_add_u32 s3, s3, 4194304
    v_bfe_u32 v232, v0, 4, 1
    v_mul_u32_u24 v232, 20480, v232
    s_lshl_b32 s4, s94, 2
    s_add_u32 s4, s4, s97
    s_lshl_b32 s5, s4, 9
    s_add_u32 s5, s5, s3
    v_lshl_add_u32 v14, v2, 8, v232
    v_lshl_add_u32 v14, v3, 4, v14
    v_add_u32 v14, s5, v14
    s_lshl_b32 s5, s4, 7
    s_add_u32 s5, s5, s3
    s_add_u32 s5, s5, 16384
    v_lshl_add_u32 v15, v3, 3, v232
    v_add_u32 v15, s5, v15
    v_lshlrev_b32 v246, 2, v3
    v_lshlrev_b32 v247, 2, v1
    s_add_u32 s16, s23, 1
    s_sub_u32 s100, s16, 10
    s_cselect_b32 s16, s16, s100
    s_mul_i32 s100, s16, 81920
    s_lshl_b32 s16, s16, 7
    s_mov_b64 exec, s[28:29]
    s_add_u32 m0, s20, 94208
    s_nop 0
    buffer_load_dwordx4 v205, s[40:43], s100 offen lds
    s_add_u32 s100, s100, 5120
    s_add_u32 m0, s20, 94976
    s_nop 0
    buffer_load_dwordx4 v205, s[40:43], s100 offen lds
    s_add_u32 m0, s15, 8192
    s_mov_b64 exec, s[10:11]
    buffer_load_dwordx4 v204, s[36:39], s16 offen lds
    s_mov_b64 exec, -1
    s_waitcnt vmcnt(6)
    s_barrier
    ds_read_b128 v[144:147], v96
    ds_read_b64_tr_b16 v[164:165], v61 offset:0
    ds_read_b64_tr_b16 v[166:167], v61 offset:160
    ds_read_b128 v[148:151], v97
    ds_read_b64_tr_b16 v[168:169], v61 offset:5120
    ds_read_b64_tr_b16 v[170:171], v61 offset:5280
    ds_read_b128 v[152:155], v98
    ds_read_b64_tr_b16 v[172:173], v61 offset:10240
    ds_read_b64_tr_b16 v[174:175], v61 offset:10400
    ds_read_b128 v[156:159], v99
    ds_read_b64_tr_b16 v[176:177], v61 offset:15360
    ds_read_b64_tr_b16 v[178:179], v61 offset:15520
    ds_read_b128 v[160:163], v100
    ds_read_b64_tr_b16 v[180:181], v61 offset:20480
    ds_read_b64_tr_b16 v[182:183], v61 offset:20640
    s_cmp_lt_u32 s94, 4
    s_cbranch_scc0 kv_v
    s_waitcnt lgkmcnt(12)
    v_mfma_f32_16x16x32_bf16 v[32:35], v[164:167], v[144:147], 0
    s_waitcnt lgkmcnt(9)
    v_mfma_f32_16x16x32_bf16 v[32:35], v[168:171], v[148:151], v[32:35]
    s_waitcnt lgkmcnt(6)
    v_mfma_f32_16x16x32_bf16 v[32:35], v[172:175], v[152:155], v[32:35]
    s_waitcnt lgkmcnt(3)
    v_mfma_f32_16x16x32_bf16 v[32:35], v[176:179], v[156:159], v[32:35]
    s_waitcnt lgkmcnt(0)
    v_mfma_f32_16x16x32_bf16 v[32:35], v[180:183], v[160:163], v[32:35]
    s_branch kv_j
kv_v:
    s_waitcnt lgkmcnt(12)
    v_mfma_f32_16x16x32_bf16 v[32:35], v[144:147], v[164:167], 0
    s_waitcnt lgkmcnt(9)
    v_mfma_f32_16x16x32_bf16 v[32:35], v[148:151], v[168:171], v[32:35]
    s_waitcnt lgkmcnt(6)
    v_mfma_f32_16x16x32_bf16 v[32:35], v[152:155], v[172:175], v[32:35]
    s_waitcnt lgkmcnt(3)
    v_mfma_f32_16x16x32_bf16 v[32:35], v[156:159], v[176:179], v[32:35]
    s_waitcnt lgkmcnt(0)
    v_mfma_f32_16x16x32_bf16 v[32:35], v[160:163], v[180:183], v[32:35]
kv_j:
    s_nop 7
    ds_write_b128 v63, v[32:35]
    s_waitcnt lgkmcnt(0)
    s_barrier
    s_cmp_lg_u32 s19, 0
    s_cbranch_scc1 kv_r1
    v_cmp_gt_u32 vcc, 20, v12
    ds_read_b128 v[64:67], v9 offset:0
    ds_read_b128 v[68:71], v9 offset:512
    ds_read_b128 v[72:75], v9 offset:2048
    ds_read_b128 v[76:79], v9 offset:2560
    ds_read_b128 v[80:83], v9 offset:4096
    ds_read_b128 v[84:87], v9 offset:4608
    ds_read_b128 v[88:91], v9 offset:6144
    ds_read_b128 v[92:95], v9 offset:6656
    s_waitcnt vmcnt(0)
    buffer_load_dword v225, v13, s[68:71], 0 offen sc1
    s_waitcnt lgkmcnt(5)
    v_add_f32 v64, v64, v72
    v_add_f32 v65, v65, v73
    v_add_f32 v66, v66, v74
    v_add_f32 v67, v67, v75
    s_waitcnt lgkmcnt(4)
    v_add_f32 v68, v68, v76
    v_add_f32 v69, v69, v77
    v_add_f32 v70, v70, v78
    v_add_f32 v71, v71, v79
    s_waitcnt lgkmcnt(1)
    v_add_f32 v80, v80, v88
    v_add_f32 v81, v81, v89
    v_add_f32 v82, v82, v90
    v_add_f32 v83, v83, v91
    s_waitcnt lgkmcnt(0)
    v_add_f32 v84, v84, v92
    v_add_f32 v85, v85, v93
    v_add_f32 v86, v86, v94
    v_add_f32 v87, v87, v95
    v_add_f32 v64, v64, v80
    v_add_f32 v65, v65, v81
    v_add_f32 v66, v66, v82
    v_add_f32 v67, v67, v83
    v_add_f32 v68, v68, v84
    v_add_f32 v69, v69, v85
    v_add_f32 v70, v70, v86
    v_add_f32 v71, v71, v87
    v_cvt_pk_bf16_f32 v72, v64, v65
    v_cvt_pk_bf16_f32 v73, v66, v67
    v_cvt_pk_bf16_f32 v74, v68, v69
    v_cvt_pk_bf16_f32 v75, v70, v71
    s_cmp_lt_u32 s94, 4
    s_cbranch_scc0 kvr_v
    s_mov_b32 exec_hi, 0xffff0000
    s_mov_b32 exec_lo, 0
    v_mov_b32 v72, 0x3f803f80
    v_mov_b32 v73, 0x00003f80
    s_mov_b64 exec, -1
    buffer_store_dwordx4 v[72:75], v10, s[64:67], 0 offen sc1
    buffer_store_dwordx2 v[72:73], v11, s[64:67], 0 offen offset:2560 sc1
    s_branch kvr_j
kvr_v:
    v_cndmask_b32 v72, v11, v72, vcc
    v_cndmask_b32 v73, v11, v73, vcc
    v_cndmask_b32 v74, v11, v74, vcc
    v_cndmask_b32 v75, v11, v75, vcc
    s_mov_b64 exec, s[10:11]
    buffer_store_dwordx4 v[72:75], v10, s[64:67], 0 offen offset:1024 sc1
    s_mov_b64 exec, -1
kvr_j:
    s_branch kv_rj
kv_r1:
    s_cmp_lg_u32 s19, 1
    s_cbranch_scc1 kv_r2
    v_cmp_gt_u32 vcc, 32, v0
    v_cmp_gt_u32 s[4:5], 48, v0
    s_mov_b32 s3, 278528
    ds_read_b128 v[64:67], v9 offset:0
    ds_read_b128 v[68:71], v9 offset:512
    ds_read_b128 v[72:75], v9 offset:2048
    ds_read_b128 v[76:79], v9 offset:2560
    ds_read_b128 v[80:83], v9 offset:4096
    ds_read_b128 v[84:87], v9 offset:4608
    ds_read_b128 v[88:91], v9 offset:6144
    ds_read_b128 v[92:95], v9 offset:6656
    s_waitcnt vmcnt(0)
    buffer_load_dword v225, v13, s[68:71], 0 offen sc1
    s_waitcnt lgkmcnt(5)
    v_add_f32 v64, v64, v72
    v_add_f32 v65, v65, v73
    v_add_f32 v66, v66, v74
    v_add_f32 v67, v67, v75
    s_waitcnt lgkmcnt(4)
    v_add_f32 v68, v68, v76
    v_add_f32 v69, v69, v77
    v_add_f32 v70, v70, v78
    v_add_f32 v71, v71, v79
    s_waitcnt lgkmcnt(1)
    v_add_f32 v80, v80, v88
    v_add_f32 v81, v81, v89
    v_add_f32 v82, v82, v90
    v_add_f32 v83, v83, v91
    s_waitcnt lgkmcnt(0)
    v_add_f32 v84, v84, v92
    v_add_f32 v85, v85, v93
    v_add_f32 v86, v86, v94
    v_add_f32 v87, v87, v95
    v_add_f32 v64, v64, v80
    v_add_f32 v65, v65, v81
    v_add_f32 v66, v66, v82
    v_add_f32 v67, v67, v83
    v_add_f32 v68, v68, v84
    v_add_f32 v69, v69, v85
    v_add_f32 v70, v70, v86
    v_add_f32 v71, v71, v87
    v_mul_f32 v236, v64, v64
    v_mul_f32 v237, v68, v68
    v_fmac_f32 v236, v65, v65
    v_fmac_f32 v237, v69, v69
    v_fmac_f32 v236, v66, v66
    v_fmac_f32 v237, v70, v70
    v_fmac_f32 v236, v67, v67
    v_fmac_f32 v237, v71, v71
    v_cndmask_b32 v237, 0, v237, vcc
    v_add_f32 v236, v236, v237
    v_cndmask_b32 v236, 0, v236, s[4:5]
    v_mov_b32 v237, v236
    s_nop 1
    v_permlane32_swap_b32 v236, v237
    v_add_f32 v236, v236, v237
    v_mov_b32 v237, v236
    s_nop 1
    v_permlane16_swap_b32 v236, v237
    v_add_f32 v236, v236, v237
    s_nop 1
    v_max_f32_dpp v236, v236, v236 row_ror:8 row_mask:0xf bank_mask:0xf
    s_nop 1
    v_max_f32_dpp v236, v236, v236 row_ror:4 row_mask:0xf bank_mask:0xf
    s_nop 1
    v_max_f32_dpp v236, v236, v236 row_ror:2 row_mask:0xf bank_mask:0xf
    s_nop 1
    v_max_f32_dpp v236, v236, v236 row_ror:1 row_mask:0xf bank_mask:0xf
    s_mov_b64 exec, 0xffff
    buffer_store_dword v236, v12, s[64:67], s3 offen sc1
    s_mov_b64 exec, -1
    s_branch kv_rj
kv_r2:
    s_cmp_lg_u32 s19, 2
    s_cbranch_scc1 kv_rj
    ds_read_b128 v[40:43], v62 offset:0
    ds_read_b128 v[44:47], v62 offset:256
    ds_read_b128 v[48:51], v62 offset:512
    ds_read_b128 v[52:55], v62 offset:768
    ds_read_b128 v[56:59], v62 offset:1024
    s_waitcnt lgkmcnt(4)
    v_mfma_f32_16x16x32_bf16 v[36:39], v[40:43], v[144:147], 0
    s_waitcnt lgkmcnt(3)
    v_mfma_f32_16x16x32_bf16 v[36:39], v[44:47], v[148:151], v[36:39]
    s_waitcnt lgkmcnt(2)
    v_mfma_f32_16x16x32_bf16 v[36:39], v[48:51], v[152:155], v[36:39]
    s_waitcnt lgkmcnt(1)
    v_mfma_f32_16x16x32_bf16 v[36:39], v[52:55], v[156:159], v[36:39]
    s_waitcnt lgkmcnt(0)
    v_mfma_f32_16x16x32_bf16 v[36:39], v[56:59], v[160:163], v[36:39]
    s_nop 7
    ds_write_b32 v8, v36
kv_rj:
    s_add_u32 s16, s23, 2
    s_sub_u32 s100, s16, 10
    s_cselect_b32 s16, s16, s100
    s_mul_i32 s100, s16, 81920
    s_lshl_b32 s16, s16, 7
    s_mov_b64 exec, s[28:29]
    s_add_u32 m0, s20, 106496
    s_nop 0
    buffer_load_dwordx4 v205, s[40:43], s100 offen lds
    s_add_u32 s100, s100, 5120
    s_add_u32 m0, s20, 107264
    s_nop 0
    buffer_load_dwordx4 v205, s[40:43], s100 offen lds
    s_add_u32 m0, s15, 16384
    s_mov_b64 exec, s[10:11]
    buffer_load_dwordx4 v204, s[36:39], s16 offen lds
    s_mov_b64 exec, -1
    s_cmp_lt_u32 s19, 2
    s_cbranch_scc1 kv_nw
    s_waitcnt vmcnt(3)
kv_nw:
    s_waitcnt lgkmcnt(0)
    s_barrier
    ds_read_b64_tr_b16 v[32:33], v192 offset:0
    ds_read_b64_tr_b16 v[34:35], v192 offset:768
    ds_read_b128 v[36:39], v216 offset:0
    ds_read_b64_tr_b16 v[40:41], v192 offset:3072
    ds_read_b64_tr_b16 v[42:43], v192 offset:3840
    ds_read_b128 v[44:47], v217 offset:0
    s_add_u32 s16, s23, 3
    s_sub_u32 s100, s16, 10
    s_cselect_b32 s16, s16, s100
    s_mul_i32 s100, s16, 81920
    s_lshl_b32 s16, s16, 7
    s_mov_b64 exec, s[28:29]
    s_add_u32 m0, s20, 118784
    s_nop 0
    buffer_load_dwordx4 v205, s[40:43], s100 offen lds
    s_add_u32 s100, s100, 5120
    s_add_u32 m0, s20, 119552
    s_nop 0
    buffer_load_dwordx4 v205, s[40:43], s100 offen lds
    s_add_u32 m0, s15, 24576
    s_mov_b64 exec, s[10:11]
    buffer_load_dwordx4 v204, s[36:39], s16 offen lds
    s_mov_b64 exec, -1
    ds_read_b64_tr_b16 v[48:49], v192 offset:6144
    ds_read_b64_tr_b16 v[50:51], v192 offset:6912
    ds_read_b128 v[52:55], v218 offset:0
    ds_read_b64_tr_b16 v[56:57], v192 offset:9216
    ds_read_b64_tr_b16 v[58:59], v192 offset:9984
    ds_read_b128 v[60:63], v219 offset:0
    s_add_u32 s16, s23, 4
    s_sub_u32 s100, s16, 10
    s_cselect_b32 s16, s16, s100
    s_mul_i32 s100, s16, 81920
    s_lshl_b32 s16, s16, 7
    s_mov_b64 exec, s[28:29]
    s_add_u32 m0, s20, 131072
    s_nop 0
    buffer_load_dwordx4 v205, s[40:43], s100 offen lds
    s_add_u32 s100, s100, 5120
    s_add_u32 m0, s20, 131840
    s_nop 0
    buffer_load_dwordx4 v205, s[40:43], s100 offen lds
    s_add_u32 m0, s15, 32768
    s_mov_b64 exec, s[10:11]
    buffer_load_dwordx4 v204, s[36:39], s16 offen lds
    s_mov_b64 exec, -1
    s_waitcnt lgkmcnt(9)
    v_mfma_f32_32x32x16_bf16 v[96:111], v[32:35], v[36:39], 0
    ds_read_b64_tr_b16 v[64:65], v192 offset:12288
    ds_read_b64_tr_b16 v[66:67], v192 offset:13056
    ds_read_b128 v[68:71], v216 offset:8192
    s_waitcnt lgkmcnt(9)
    v_mfma_f32_32x32x16_bf16 v[96:111], v[40:43], v[44:47], v[96:111]
    ds_read_b64_tr_b16 v[72:73], v192 offset:15360
    ds_read_b64_tr_b16 v[74:75], v192 offset:16128
    ds_read_b128 v[76:79], v217 offset:8192
    s_cmp_gt_u32 s19, 1
    s_cbranch_scc1 kv_skip2
    s_and_b32 s3, s2, 15
    s_lshl_b32 s3, s3, 8
    s_add_u32 s3, s3, 294912
    v_mov_b32 v232, s3
    s_cmp_lt_u32 s94, 4
    s_cselect_b32 s3, 1, 2
    v_mov_b32 v233, s3
    s_mov_b32 s17, 0
    s_waitcnt vmcnt(9)
kv_rdy:
    v_cmp_ne_u32 vcc, 0, v225
    s_add_u32 s17, s17, 1
    s_cmp_gt_u32 s17, 1048576
    s_cbranch_vccnz kv_go
    s_cbranch_scc1 kv_go
    buffer_load_dword v225, v13, s[68:71], 0 offen sc1
    s_waitcnt vmcnt(0)
    s_branch kv_rdy
kv_go:
    s_mov_b64 exec, 1
    buffer_atomic_add v233, v232, s[64:67], 0 offen sc1
    s_mov_b64 exec, -1
kv_skip2:
    s_waitcnt lgkmcnt(9)
    v_mfma_f32_32x32x16_bf16 v[96:111], v[48:51], v[52:55], v[96:111]
    ds_read_b64_tr_b16 v[80:81], v192 offset:18432
    ds_read_b64_tr_b16 v[82:83], v192 offset:19200
    ds_read_b128 v[84:87], v218 offset:8192
    s_waitcnt lgkmcnt(9)
    v_mfma_f32_32x32x16_bf16 v[96:111], v[56:59], v[60:63], v[96:111]
    ds_read_b64_tr_b16 v[88:89], v192 offset:21504
    ds_read_b64_tr_b16 v[90:91], v192 offset:22272
    ds_read_b128 v[92:95], v219 offset:8192
    s_add_u32 s16, s23, 5
    s_sub_u32 s100, s16, 10
    s_cselect_b32 s16, s16, s100
    s_mul_i32 s100, s16, 81920
    s_lshl_b32 s16, s16, 7
    s_mov_b64 exec, s[28:29]
    s_add_u32 m0, s20, 143360
    s_nop 0
    buffer_load_dwordx4 v205, s[40:43], s100 offen lds
    s_add_u32 s100, s100, 5120
    s_add_u32 m0, s20, 144128
    s_nop 0
    buffer_load_dwordx4 v205, s[40:43], s100 offen lds
    s_add_u32 m0, s15, 40960
    s_mov_b64 exec, s[10:11]
    buffer_load_dwordx4 v204, s[36:39], s16 offen lds
    s_mov_b64 exec, -1
    s_cmp_lt_u32 s94, 4
    s_cselect_b32 s3, s92, 0
    s_cmp_lg_u32 s3, 3
    s_cbranch_scc1 gf_skip
    v_lshlrev_b32 v236, 2, v3
    v_add_u32 v236, 155648, v236
    ds_read_b32 v232, v236 offset:0
    ds_read_b32 v233, v236 offset:256
    ds_read_b32 v234, v236 offset:512
    s_waitcnt lgkmcnt(8)
    ds_read_b32 v235, v236 offset:768
    s_mov_b32 s3, 262144
    s_waitcnt lgkmcnt(2)
    v_add_f32 v232, v232, v233
    s_waitcnt lgkmcnt(0)
    v_add_f32 v234, v234, v235
    v_add_f32 v232, v232, v234
    v_cvt_pk_bf16_f32 v232, v232, v232
    v_lshlrev_b32 v232, 16, v232
    v_mul_f32 v232, 0xbfb8aa3b, v232
    v_exp_f32 v232, v232
    s_nop 0
    v_add_f32 v232, 1.0, v232
    v_rcp_f32 v232, v232
    s_nop 0
    v_cvt_pk_bf16_f32 v232, v232, v232
    v_lshlrev_b32 v232, 16, v232
    s_mov_b64 exec, 0xffff
    buffer_store_dword v232, v12, s[64:67], s3 offen sc1
    s_mov_b64 exec, -1
gf_skip:
    s_waitcnt vmcnt(6) lgkmcnt(0)
    s_barrier
    v_mfma_f32_32x32x16_bf16 v[96:111], v[64:67], v[68:71], v[96:111]
    ds_read_b64_tr_b16 v[32:33], v192 offset:24576
    ds_read_b64_tr_b16 v[34:35], v192 offset:25344
    ds_read_b128 v[36:39], v216 offset:16384
    v_fmamk_f32 v196, v194, 0x41800000, v195
    v_fmamk_f32 v197, v194, 0x42400000, v195
    v_fmamk_f32 v198, v194, 0x41a00000, v195
    v_fmamk_f32 v199, v194, 0x42500000, v195
    v_fmamk_f32 v200, v194, 0x41c00000, v195
    v_fmamk_f32 v201, v194, 0x42600000, v195
    v_mfma_f32_32x32x16_bf16 v[96:111], v[72:75], v[76:79], v[96:111]
    ds_read_b64_tr_b16 v[40:41], v192 offset:27648
    ds_read_b64_tr_b16 v[42:43], v192 offset:28416
    ds_read_b128 v[44:47], v217 offset:16384
    s_add_u32 s16, s23, 6
    s_sub_u32 s100, s16, 10
    s_cselect_b32 s16, s16, s100
    s_mul_i32 s100, s16, 81920
    s_lshl_b32 s16, s16, 7
    s_mov_b64 exec, s[28:29]
    s_add_u32 m0, s20, 81920
    s_nop 0
    buffer_load_dwordx4 v205, s[40:43], s100 offen lds
    s_add_u32 s100, s100, 5120
    s_add_u32 m0, s20, 82688
    s_nop 0
    buffer_load_dwordx4 v205, s[40:43], s100 offen lds
    s_add_u32 m0, s15, 49152
    s_mov_b64 exec, s[10:11]
    buffer_load_dwordx4 v204, s[36:39], s16 offen lds
    s_mov_b64 exec, -1
    v_mfma_f32_32x32x16_bf16 v[96:111], v[80:83], v[84:87], v[96:111]
    ds_read_b64_tr_b16 v[48:49], v192 offset:30720
    ds_read_b64_tr_b16 v[50:51], v192 offset:31488
    ds_read_b128 v[52:55], v218 offset:16384
    v_fmamk_f32 v202, v194, 0x41e00000, v195
    v_fmamk_f32 v203, v194, 0x42700000, v195
    v_cos_f32 v196, v196
    v_cos_f32 v197, v197
    v_cos_f32 v198, v198
    v_cvt_pk_bf16_f32 v140, v196, v197
    v_mfma_f32_32x32x16_bf16 v[96:111], v[88:91], v[92:95], v[96:111]
    ds_read_b64_tr_b16 v[56:57], v192 offset:33792
    ds_read_b64_tr_b16 v[58:59], v192 offset:34560
    ds_read_b128 v[60:63], v219 offset:16384
    s_add_u32 s16, s23, 7
    s_sub_u32 s100, s16, 10
    s_cselect_b32 s16, s16, s100
    s_mul_i32 s100, s16, 81920
    s_lshl_b32 s16, s16, 7
    s_mov_b64 exec, s[28:29]
    s_add_u32 m0, s20, 94208
    s_nop 0
    buffer_load_dwordx4 v205, s[40:43], s100 offen lds
    s_add_u32 s100, s100, 5120
    s_add_u32 m0, s20, 94976
    s_nop 0
    buffer_load_dwordx4 v205, s[40:43], s100 offen lds
    s_add_u32 m0, s15, 57344
    s_mov_b64 exec, s[10:11]
    buffer_load_dwordx4 v204, s[36:39], s16 offen lds
    s_mov_b64 exec, -1
    s_waitcnt lgkmcnt(9)
    v_mfma_f32_32x32x16_bf16 v[96:111], v[32:35], v[36:39], v[96:111]
    ds_read_b64_tr_b16 v[64:65], v193 offset:0
    ds_read_b64_tr_b16 v[66:67], v193 offset:768
    ds_read_b128 v[68:71], v216 offset:24576
    v_cos_f32 v199, v199
    v_cos_f32 v200, v200
    v_cvt_pk_bf16_f32 v141, v198, v199
    v_cos_f32 v201, v201
    v_cos_f32 v202, v202
    v_cvt_pk_bf16_f32 v142, v200, v201
    s_waitcnt lgkmcnt(9)
    v_mfma_f32_32x32x16_bf16 v[96:111], v[40:43], v[44:47], v[96:111]
    ds_read_b64_tr_b16 v[72:73], v193 offset:3072
    ds_read_b64_tr_b16 v[74:75], v193 offset:3840
    ds_read_b128 v[76:79], v217 offset:24576
    v_cos_f32 v203, v203
    s_nop 0
    v_cvt_pk_bf16_f32 v143, v202, v203
    v_bfe_u32 v232, v0, 2, 2
    v_mul_u32_u24 v232, 160, v232
    v_and_b32 v233, 3, v0
    v_lshl_add_u32 v232, v233, 3, v232
    s_waitcnt lgkmcnt(9)
    v_mfma_f32_32x32x16_bf16 v[96:111], v[48:51], v[52:55], v[96:111]
    ds_read_b64_tr_b16 v[80:81], v193 offset:6144
    ds_read_b64_tr_b16 v[82:83], v193 offset:6912
    ds_read_b128 v[84:87], v218 offset:24576
    s_mul_i32 s7, s35, 51200
    v_add_u32 v232, s7, v232
    v_and_b32 v233, 1, v4
    v_mul_u32_u24 v234, 3200, v2
    s_movk_i32 s7, 640
    v_mad_u32_u24 v234, v233, s7, v234
    s_waitcnt lgkmcnt(9)
    v_mfma_f32_32x32x16_bf16 v[96:111], v[56:59], v[60:63], v[96:111]
    ds_read_b64_tr_b16 v[88:89], v193 offset:9216
    ds_read_b64_tr_b16 v[90:91], v193 offset:9984
    ds_read_b128 v[92:95], v219 offset:24576
    v_add_u32 v234, v234, v232
    v_mul_u32_u24 v235, 12800, v2
    v_add_u32 v232, v235, v232
    s_movk_i32 s7, 9600
    v_mad_u32_u24 v235, v233, s7, v232
    s_movk_i32 s7, 3200
    s_waitcnt vmcnt(6) lgkmcnt(0)
    s_barrier
    v_mfma_f32_32x32x16_bf16 v[96:111], v[64:67], v[68:71], v[96:111]
    ds_read_b64_tr_b16 v[32:33], v193 offset:12288
    ds_read_b64_tr_b16 v[34:35], v193 offset:13056
    ds_read_b128 v[36:39], v216 offset:32768
    v_mad_u32_u24 v236, v233, s7, v232
    v_mfma_f32_32x32x16_bf16 v[96:111], v[72:75], v[76:79], v[96:111]
    ds_read_b64_tr_b16 v[40:41], v193 offset:15360
    ds_read_b64_tr_b16 v[42:43], v193 offset:16128
    ds_read_b128 v[44:47], v217 offset:32768
    s_add_u32 s16, s23, 8
    s_sub_u32 s100, s16, 10
    s_cselect_b32 s16, s16, s100
    s_mul_i32 s100, s16, 81920
    s_lshl_b32 s16, s16, 7
    s_mov_b64 exec, s[28:29]
    s_add_u32 m0, s20, 106496
    s_nop 0
    buffer_load_dwordx4 v205, s[40:43], s100 offen lds
    s_add_u32 s100, s100, 5120
    s_add_u32 m0, s20, 107264
    s_nop 0
    buffer_load_dwordx4 v205, s[40:43], s100 offen lds
    s_add_u32 m0, s15, 65536
    s_mov_b64 exec, s[10:11]
    buffer_load_dwordx4 v204, s[36:39], s16 offen lds
    s_mov_b64 exec, -1
    v_mfma_f32_32x32x16_bf16 v[96:111], v[80:83], v[84:87], v[96:111]
    ds_read_b64_tr_b16 v[48:49], v193 offset:18432
    ds_read_b64_tr_b16 v[50:51], v193 offset:19200
    ds_read_b128 v[52:55], v218 offset:32768
    v_mfma_f32_32x32x16_bf16 v[96:111], v[88:91], v[92:95], v[96:111]
    ds_read_b64_tr_b16 v[56:57], v193 offset:21504
    ds_read_b64_tr_b16 v[58:59], v193 offset:22272
    ds_read_b128 v[60:63], v219 offset:32768
    s_add_u32 s16, s23, 9
    s_sub_u32 s100, s16, 10
    s_cselect_b32 s16, s16, s100
    s_mul_i32 s100, s16, 81920
    s_lshl_b32 s16, s16, 7
    s_mov_b64 exec, s[28:29]
    s_add_u32 m0, s20, 118784
    s_nop 0
    buffer_load_dwordx4 v205, s[40:43], s100 offen lds
    s_add_u32 s100, s100, 5120
    s_add_u32 m0, s20, 119552
    s_nop 0
    buffer_load_dwordx4 v205, s[40:43], s100 offen lds
    s_add_u32 m0, s15, 73728
    s_mov_b64 exec, s[10:11]
    buffer_load_dwordx4 v204, s[36:39], s16 offen lds
    s_mov_b64 exec, -1
    s_waitcnt lgkmcnt(9)
    v_mfma_f32_32x32x16_bf16 v[96:111], v[32:35], v[36:39], v[96:111]
    ds_read_b64_tr_b16 v[64:65], v193 offset:24576
    ds_read_b64_tr_b16 v[66:67], v193 offset:25344
    ds_read_b128 v[68:71], v216 offset:40960
    s_waitcnt lgkmcnt(9)
    v_mfma_f32_32x32x16_bf16 v[96:111], v[40:43], v[44:47], v[96:111]
    ds_read_b64_tr_b16 v[72:73], v193 offset:27648
    ds_read_b64_tr_b16 v[74:75], v193 offset:28416
    ds_read_b128 v[76:79], v217 offset:40960
    s_waitcnt lgkmcnt(9)
    v_mfma_f32_32x32x16_bf16 v[96:111], v[48:51], v[52:55], v[96:111]
    ds_read_b64_tr_b16 v[80:81], v193 offset:30720
    ds_read_b64_tr_b16 v[82:83], v193 offset:31488
    ds_read_b128 v[84:87], v218 offset:40960
    s_waitcnt lgkmcnt(9)
    v_mfma_f32_32x32x16_bf16 v[96:111], v[56:59], v[60:63], v[96:111]
    ds_read_b64_tr_b16 v[88:89], v193 offset:33792
    ds_read_b64_tr_b16 v[90:91], v193 offset:34560
    ds_read_b128 v[92:95], v219 offset:40960
    s_cmp_lg_u32 s92, 7
    s_cbranch_scc1 s1l
    buffer_load_dword v227, v226, s[64:67], 0 offen sc1
s1l:
    s_waitcnt vmcnt(6) lgkmcnt(0)
    s_barrier
    v_mfma_f32_32x32x16_bf16 v[96:111], v[64:67], v[68:71], v[96:111]
    ds_read_b64_tr_b16 v[32:33], v192 offset:0
    ds_read_b64_tr_b16 v[34:35], v192 offset:768
    ds_read_b128 v[36:39], v216 offset:49152
    v_mfma_f32_32x32x16_bf16 v[96:111], v[72:75], v[76:79], v[96:111]
    ds_read_b64_tr_b16 v[40:41], v192 offset:3072
    ds_read_b64_tr_b16 v[42:43], v192 offset:3840
    ds_read_b128 v[44:47], v217 offset:49152
    v_mfma_f32_32x32x16_bf16 v[96:111], v[80:83], v[84:87], v[96:111]
    ds_read_b64_tr_b16 v[48:49], v192 offset:6144
    ds_read_b64_tr_b16 v[50:51], v192 offset:6912
    ds_read_b128 v[52:55], v218 offset:49152
    v_mfma_f32_32x32x16_bf16 v[96:111], v[88:91], v[92:95], v[96:111]
    ds_read_b64_tr_b16 v[56:57], v192 offset:9216
    ds_read_b64_tr_b16 v[58:59], v192 offset:9984
    ds_read_b128 v[60:63], v219 offset:49152
    s_waitcnt lgkmcnt(9)
    v_mfma_f32_32x32x16_bf16 v[96:111], v[32:35], v[36:39], v[96:111]
    ds_read_b64_tr_b16 v[64:65], v192 offset:12288
    ds_read_b64_tr_b16 v[66:67], v192 offset:13056
    ds_read_b128 v[68:71], v216 offset:57344
    s_waitcnt lgkmcnt(9)
    v_mfma_f32_32x32x16_bf16 v[96:111], v[40:43], v[44:47], v[96:111]
    ds_read_b64_tr_b16 v[72:73], v192 offset:15360
    ds_read_b64_tr_b16 v[74:75], v192 offset:16128
    ds_read_b128 v[76:79], v217 offset:57344
    s_waitcnt lgkmcnt(9)
    v_mfma_f32_32x32x16_bf16 v[96:111], v[48:51], v[52:55], v[96:111]
    ds_read_b64_tr_b16 v[80:81], v192 offset:18432
    ds_read_b64_tr_b16 v[82:83], v192 offset:19200
    ds_read_b128 v[84:87], v218 offset:57344
    s_waitcnt lgkmcnt(9)
    v_mfma_f32_32x32x16_bf16 v[96:111], v[56:59], v[60:63], v[96:111]
    ds_read_b64_tr_b16 v[88:89], v192 offset:21504
    ds_read_b64_tr_b16 v[90:91], v192 offset:22272
    ds_read_b128 v[92:95], v219 offset:57344
    s_cmp_lg_u32 s92, 7
    s_cbranch_scc1 s1_skip
    s_waitcnt vmcnt(0)
    v_cmp_gt_u32 vcc, 32, v227
    s_nop 0
    s_cbranch_vccz s1_out
    s_cmp_lg_u32 s92, 7
    s_cbranch_scc1 s1_skip
    s_mov_b32 s17, 0
s1_l:
    buffer_load_dword v227, v226, s[64:67], 0 offen sc1
    s_add_u32 s17, s17, 1
    s_cmp_gt_u32 s17, 1048576
    s_waitcnt vmcnt(0)
    v_cmp_gt_u32 vcc, 32, v227
    s_cbranch_scc1 s1_out
    s_cbranch_vccnz s1_l
s1_out:
s1_skip:
    s_waitcnt vmcnt(0) lgkmcnt(0)
    s_barrier
    v_mfma_f32_32x32x16_bf16 v[96:111], v[64:67], v[68:71], v[96:111]
    ds_read_b64_tr_b16 v[32:33], v192 offset:24576
    ds_read_b64_tr_b16 v[34:35], v192 offset:25344
    ds_read_b128 v[36:39], v184 offset:0
    v_mfma_f32_32x32x16_bf16 v[96:111], v[72:75], v[76:79], v[96:111]
    ds_read_b64_tr_b16 v[40:41], v192 offset:27648
    ds_read_b64_tr_b16 v[42:43], v192 offset:28416
    ds_read_b128 v[44:47], v185 offset:0
    s_cmp_lg_u32 s92, 7
    s_cbranch_scc1 km_skip
    v_lshlrev_b32 v232, 6, v0
    s_mov_b32 s3, 278528
    s_mov_b32 s4, 282624
    buffer_load_dword v244, v232, s[64:67], s3 offen sc1
    buffer_load_dword v245, v232, s[64:67], s4 offen sc1
km_skip:
    s_add_u32 m0, s15, 133120
    s_mov_b64 exec, s[10:11]
    buffer_load_dwordx4 v206, s[64:67], 0 offen sc1 lds
    s_mov_b64 exec, -1
    s_add_u32 m0, s15, 139264
    s_mov_b32 s16, 6144
    s_mov_b64 exec, s[10:11]
    buffer_load_dwordx4 v206, s[64:67], s16 offen sc1 lds
    s_mov_b64 exec, -1
    s_add_u32 m0, s15, 145408
    s_mov_b32 s16, 12288
    s_mov_b64 exec, s[10:11]
    buffer_load_dwordx4 v206, s[64:67], s16 offen sc1 lds
    s_mov_b64 exec, -1
    s_add_u32 m0, s15, 151552
    s_mov_b32 s16, 18432
    s_mov_b64 exec, s[10:11]
    buffer_load_dwordx4 v206, s[64:67], s16 offen sc1 lds
    s_mov_b64 exec, -1
    v_mfma_f32_32x32x16_bf16 v[96:111], v[80:83], v[84:87], v[96:111]
    ds_read_b64_tr_b16 v[48:49], v192 offset:30720
    ds_read_b64_tr_b16 v[50:51], v192 offset:31488
    ds_read_b128 v[52:55], v186 offset:0
    v_mfma_f32_32x32x16_bf16 v[96:111], v[88:91], v[92:95], v[96:111]
    ds_read_b64_tr_b16 v[56:57], v192 offset:33792
    ds_read_b64_tr_b16 v[58:59], v192 offset:34560
    ds_read_b128 v[60:63], v187 offset:0
    s_waitcnt lgkmcnt(9)
    v_mfma_f32_32x32x16_bf16 v[96:111], v[32:35], v[36:39], v[96:111]
    ds_read_b64_tr_b16 v[64:65], v193 offset:0
    ds_read_b64_tr_b16 v[66:67], v193 offset:768
    ds_read_b128 v[68:71], v184 offset:8192
    s_waitcnt lgkmcnt(9)
    v_mfma_f32_32x32x16_bf16 v[96:111], v[40:43], v[44:47], v[96:111]
    ds_read_b64_tr_b16 v[72:73], v193 offset:3072
    ds_read_b64_tr_b16 v[74:75], v193 offset:3840
    ds_read_b128 v[76:79], v185 offset:8192
    s_waitcnt lgkmcnt(9)
    v_mfma_f32_32x32x16_bf16 v[96:111], v[48:51], v[52:55], v[96:111]
    ds_read_b64_tr_b16 v[80:81], v193 offset:6144
    ds_read_b64_tr_b16 v[82:83], v193 offset:6912
    ds_read_b128 v[84:87], v186 offset:8192
    s_waitcnt lgkmcnt(9)
    v_mfma_f32_32x32x16_bf16 v[96:111], v[56:59], v[60:63], v[96:111]
    ds_read_b64_tr_b16 v[88:89], v193 offset:9216
    ds_read_b64_tr_b16 v[90:91], v193 offset:9984
    ds_read_b128 v[92:95], v187 offset:8192
    s_waitcnt lgkmcnt(9)
    v_mfma_f32_32x32x16_bf16 v[96:111], v[64:67], v[68:71], v[96:111]
    s_waitcnt lgkmcnt(6)
    v_mfma_f32_32x32x16_bf16 v[96:111], v[72:75], v[76:79], v[96:111]
    s_waitcnt lgkmcnt(3)
    v_mfma_f32_32x32x16_bf16 v[96:111], v[80:83], v[84:87], v[96:111]
    s_waitcnt lgkmcnt(0)
    v_mfma_f32_32x32x16_bf16 v[96:111], v[88:91], v[92:95], v[96:111]
    s_mov_b32 s3, 1051011932
    v_cmp_eq_u32 vcc, 0, v2
    s_nop 7
    s_nop 1
    v_mul_f32 v96, s3, v96
    v_mul_f32 v97, s3, v97
    v_mul_f32 v98, s3, v98
    v_mul_f32 v99, s3, v99
    v_mul_f32 v100, s3, v100
    v_mul_f32 v101, s3, v101
    v_mul_f32 v102, s3, v102
    v_mul_f32 v103, s3, v103
    v_mul_f32 v104, s3, v104
    v_mul_f32 v105, s3, v105
    v_mul_f32 v106, s3, v106
    v_mul_f32 v107, s3, v107
    v_cndmask_b32 v104, 0, v104, vcc
    v_cndmask_b32 v105, 0, v105, vcc
    v_cndmask_b32 v106, 0, v106, vcc
    v_cndmask_b32 v107, 0, v107, vcc
    v_mul_f32 v242, v96, v96
    v_mul_f32 v243, v97, v97
    v_fmac_f32 v242, v98, v98
    v_fmac_f32 v243, v99, v99
    v_fmac_f32 v242, v100, v100
    v_fmac_f32 v243, v101, v101
    v_fmac_f32 v242, v102, v102
    v_fmac_f32 v243, v103, v103
    v_fmac_f32 v242, v104, v104
    v_fmac_f32 v243, v105, v105
    v_fmac_f32 v242, v106, v106
    v_fmac_f32 v243, v107, v107
    v_add_f32 v242, v242, v243
    v_mov_b32 v232, v242
    v_cvt_pk_bf16_f32 v16, v96, v97
    v_cvt_pk_bf16_f32 v17, v98, v99
    v_cvt_pk_bf16_f32 v18, v100, v101
    v_permlane32_swap_b32 v242, v232
    v_cvt_pk_bf16_f32 v19, v102, v103
    v_cvt_pk_bf16_f32 v20, v104, v105
    v_cvt_pk_bf16_f32 v21, v106, v107
    v_add_f32 v242, v242, v232
    v_mov_b32 v238, 132096
    s_cmp_lg_u32 s92, 7
    s_cbranch_scc1 km_skip2
    s_waitcnt vmcnt(4)
    v_max_f32 v244, v244, v245
    v_mov_b32 v245, v244
    s_nop 1
    v_permlane32_swap_b32 v244, v245
    v_max_f32 v244, v244, v245
    v_mov_b32 v245, v244
    s_nop 1
    v_permlane16_swap_b32 v244, v245
    v_max_f32 v244, v244, v245
    s_nop 1
    v_max_f32_dpp v244, v244, v244 row_ror:8 row_mask:0xf bank_mask:0xf
    s_nop 1
    v_max_f32_dpp v244, v244, v244 row_ror:4 row_mask:0xf bank_mask:0xf
    s_nop 1
    v_max_f32_dpp v244, v244, v244 row_ror:2 row_mask:0xf bank_mask:0xf
    s_nop 1
    v_max_f32_dpp v244, v244, v244 row_ror:1 row_mask:0xf bank_mask:0xf
    v_sqrt_f32 v244, v244
    s_nop 0
    v_mul_f32 v244, 0xbf83d70a, v244
    ds_write_b32 v238, v244
km_skip2:
    s_waitcnt vmcnt(3) lgkmcnt(0)
    s_barrier
    ds_read_b32 v237, v238
    ds_read_b128 v[24:27], v211 offset:10240
    ds_read_b64 v[22:23], v212 offset:12800
    ds_read_b128 v[28:31], v7 offset:11264
    v_sqrt_f32 v242, v242
    ds_write_b128 v188, v[16:19]
    s_waitcnt lgkmcnt(4)
    v_mul_f32 v242, v237, v242
    v_cvt_pk_bf16_f32 v242, v242, 0
    v_cndmask_b32 v20, v242, v20, vcc
    ds_write_b64 v189, v[20:21] offset:1024
    s_waitcnt lgkmcnt(4)
    v_mfma_f32_32x32x16_bf16 v[32:47], v[24:27], v[16:19], 0
    ds_read_b128 v[24:27], v211 offset:13312
    s_waitcnt lgkmcnt(4)
    v_mfma_f32_32x32x8_bf16 v[32:47], v[22:23], v[20:21], v[32:47]
    ds_read_b64 v[22:23], v212 offset:15872
    s_mov_b32 s3, s92
    s_cmp_lt_u32 s3, 3
    s_cbranch_scc0 l_n
    s_nop 7
    v_exp_f32 v32, v32
    v_exp_f32 v33, v33
    v_exp_f32 v34, v34
    v_cvt_pk_bf16_f32 v64, v32, v33
    ds_read_b128 v[200:203], v7 offset:12032
    v_exp_f32 v35, v35
    v_exp_f32 v36, v36
    v_cvt_pk_bf16_f32 v65, v34, v35
    v_exp_f32 v37, v37
    v_exp_f32 v38, v38
    s_waitcnt lgkmcnt(2)
    v_mfma_f32_32x32x16_bf16 v[48:63], v[24:27], v[16:19], 0
    v_cvt_pk_bf16_f32 v66, v36, v37
    v_exp_f32 v39, v39
    v_exp_f32 v40, v40
    v_cvt_pk_bf16_f32 v67, v38, v39
    v_exp_f32 v41, v41
    s_waitcnt lgkmcnt(1)
    v_mfma_f32_32x32x8_bf16 v[48:63], v[22:23], v[20:21], v[48:63]
    v_exp_f32 v42, v42
    v_cvt_pk_bf16_f32 v68, v40, v41
    s_waitcnt vmcnt(2)
    s_barrier
    s_setprio 3
    v_exp_f32 v43, v43
    ds_read_b128 v[8:11], v190
    v_exp_f32 v44, v44
    ds_read_b128 v[24:27], v213 offset:16384
    v_cvt_pk_bf16_f32 v69, v42, v43
    v_mfma_f32_32x32x16_bf16 v[96:111], v[28:31], v[64:67], 0
    ds_read_b64 v[22:23], v214 offset:18944
    s_add_u32 m0, s15, 157696
    s_mov_b32 s16, 24576
    s_mov_b64 exec, s[10:11]
    buffer_load_dwordx4 v206, s[64:67], s16 offen sc1 lds
    s_mov_b64 exec, -1
    v_exp_f32 v45, v45
    ds_read_b128 v[28:31], v7 offset:14336
    ds_read_b64 v[12:13], v191 offset:1024
    v_exp_f32 v46, v46
    v_cvt_pk_bf16_f32 v70, v44, v45
    v_exp_f32 v47, v47
    v_exp_f32 v48, v48
    v_cvt_pk_bf16_f32 v71, v46, v47
    v_exp_f32 v49, v49
    v_exp_f32 v50, v50
    s_waitcnt lgkmcnt(5)
    v_mfma_f32_32x32x16_bf16 v[96:111], v[200:203], v[68:71], v[96:111]
    v_cvt_pk_bf16_f32 v72, v48, v49
    ds_read_b128 v[200:203], v7 offset:15104
    s_lshl_b32 s23, s23, 7
    s_add_u32 m0, s15, 81920
    s_mov_b64 exec, s[10:11]
    buffer_load_dwordx4 v208, s[56:59], s23 offen lds
    s_mov_b64 exec, -1
    v_exp_f32 v51, v51
    v_exp_f32 v52, v52
    v_cvt_pk_bf16_f32 v73, v50, v51
    v_exp_f32 v53, v53
    v_exp_f32 v54, v54
    s_waitcnt lgkmcnt(4)
    v_mfma_f32_32x32x16_bf16 v[32:47], v[24:27], v[8:11], 0
    s_setprio 2
    v_cvt_pk_bf16_f32 v74, v52, v53
    v_exp_f32 v55, v55
    v_exp_f32 v56, v56
    v_cvt_pk_bf16_f32 v75, v54, v55
    s_add_u32 m0, s15, 88064
    s_mov_b64 exec, s[10:11]
    buffer_load_dwordx4 v208, s[60:63], s23 offen lds
    s_mov_b64 exec, -1
    s_add_u32 s23, s23, 128
    s_cmp_eq_u32 s23, 1280
    s_cselect_b32 s23, 0, s23
    v_exp_f32 v57, v57
    s_waitcnt lgkmcnt(1)
    v_mfma_f32_32x32x8_bf16 v[32:47], v[22:23], v[12:13], v[32:47]
    v_exp_f32 v58, v58
    v_cvt_pk_bf16_f32 v76, v56, v57
    v_exp_f32 v59, v59
    v_exp_f32 v60, v60
    v_cvt_pk_bf16_f32 v77, v58, v59
    v_mfma_f32_32x32x16_bf16 v[96:111], v[28:31], v[72:75], v[96:111]
    v_exp_f32 v61, v61
    ds_read_b128 v[28:31], v215 offset:17408
    v_exp_f32 v62, v62
    v_cvt_pk_bf16_f32 v78, v60, v61
    v_exp_f32 v63, v63
    s_nop 0
    v_exp_f32 v32, v32
    v_cvt_pk_bf16_f32 v79, v62, v63
    v_exp_f32 v33, v33
    v_exp_f32 v34, v34
    s_setprio 1
    s_waitcnt lgkmcnt(1)
    v_mfma_f32_32x32x16_bf16 v[96:111], v[200:203], v[76:79], v[96:111]
    v_cvt_pk_bf16_f32 v64, v32, v33
    ds_read_b128 v[200:203], v215 offset:18176
    v_exp_f32 v35, v35
    v_exp_f32 v36, v36
    v_cvt_pk_bf16_f32 v65, v34, v35
    v_exp_f32 v37, v37
    v_exp_f32 v38, v38
    v_mfma_f32_32x32x16_bf16 v[48:63], v[24:27], v[16:19], 0
    v_cvt_pk_bf16_f32 v66, v36, v37
    v_exp_f32 v39, v39
    v_exp_f32 v40, v40
    v_cvt_pk_bf16_f32 v67, v38, v39
    s_setprio 0
    v_exp_f32 v41, v41
    v_mfma_f32_32x32x8_bf16 v[48:63], v[22:23], v[20:21], v[48:63]
    v_exp_f32 v42, v42
    v_cvt_pk_bf16_f32 v68, v40, v41
    s_waitcnt vmcnt(4)
    s_barrier
    s_setprio 3
    v_exp_f32 v43, v43
    v_exp_f32 v44, v44
    ds_read_b128 v[24:27], v213 offset:22528
    v_cvt_pk_bf16_f32 v69, v42, v43
    s_waitcnt lgkmcnt(2)
    v_mfma_f32_32x32x16_bf16 v[80:95], v[28:31], v[64:67], 0
    ds_read_b64 v[22:23], v214 offset:25088
    s_add_u32 m0, s15, 133120
    s_mov_b32 s16, 30720
    s_mov_b64 exec, s[10:11]
    buffer_load_dwordx4 v206, s[64:67], s16 offen sc1 lds
    s_mov_b64 exec, -1
    v_exp_f32 v45, v45
    v_exp_f32 v46, v46
    v_cvt_pk_bf16_f32 v70, v44, v45
    v_exp_f32 v47, v47
    v_exp_f32 v48, v48
    v_cvt_pk_bf16_f32 v71, v46, v47
    v_exp_f32 v49, v49
    v_exp_f32 v50, v50
    s_waitcnt lgkmcnt(2)
    v_mfma_f32_32x32x16_bf16 v[80:95], v[200:203], v[68:71], v[80:95]
    v_cvt_pk_bf16_f32 v72, v48, v49
    s_add_u32 m0, s15, 94208
    s_mov_b64 exec, s[10:11]
    buffer_load_dwordx4 v208, s[56:59], s23 offen lds
    s_mov_b64 exec, -1
    v_exp_f32 v51, v51
    v_exp_f32 v52, v52
    v_cvt_pk_bf16_f32 v73, v50, v51
    v_exp_f32 v53, v53
    v_exp_f32 v54, v54
    s_waitcnt lgkmcnt(1)
    v_mfma_f32_32x32x16_bf16 v[32:47], v[24:27], v[8:11], 0
    s_setprio 2
    v_cvt_pk_bf16_f32 v74, v52, v53
    v_exp_f32 v55, v55
    v_exp_f32 v56, v56
    v_cvt_pk_bf16_f32 v75, v54, v55
    s_add_u32 m0, s15, 100352
    s_mov_b64 exec, s[10:11]
    buffer_load_dwordx4 v208, s[60:63], s23 offen lds
    s_mov_b64 exec, -1
    s_add_u32 s23, s23, 128
    s_cmp_eq_u32 s23, 1280
    s_cselect_b32 s23, 0, s23
    v_exp_f32 v57, v57
    s_waitcnt lgkmcnt(0)
    v_mfma_f32_32x32x8_bf16 v[32:47], v[22:23], v[12:13], v[32:47]
    v_exp_f32 v58, v58
    v_cvt_pk_bf16_f32 v76, v56, v57
    v_exp_f32 v59, v59
    v_exp_f32 v60, v60
    v_cvt_pk_bf16_f32 v77, v58, v59
    v_mfma_f32_32x32x16_bf16 v[96:111], v[28:31], v[72:75], v[96:111]
    v_exp_f32 v61, v61
    ds_read_b128 v[28:31], v215 offset:23552
    v_exp_f32 v62, v62
    v_cvt_pk_bf16_f32 v78, v60, v61
    v_exp_f32 v63, v63
    s_nop 0
    v_exp_f32 v32, v32
    v_cvt_pk_bf16_f32 v79, v62, v63
    v_exp_f32 v33, v33
    v_exp_f32 v34, v34
    s_setprio 1
    v_mfma_f32_32x32x16_bf16 v[96:111], v[200:203], v[76:79], v[96:111]
    v_cvt_pk_bf16_f32 v64, v32, v33
    ds_read_b128 v[200:203], v215 offset:24320
    v_exp_f32 v35, v35
    v_exp_f32 v36, v36
    v_cvt_pk_bf16_f32 v65, v34, v35
    v_exp_f32 v37, v37
    v_exp_f32 v38, v38
    v_mfma_f32_32x32x16_bf16 v[48:63], v[24:27], v[16:19], 0
    v_cvt_pk_bf16_f32 v66, v36, v37
    v_exp_f32 v39, v39
    v_exp_f32 v40, v40
    v_cvt_pk_bf16_f32 v67, v38, v39
    s_setprio 0
    v_exp_f32 v41, v41
    v_mfma_f32_32x32x8_bf16 v[48:63], v[22:23], v[20:21], v[48:63]
    v_exp_f32 v42, v42
    v_cvt_pk_bf16_f32 v68, v40, v41
    s_waitcnt vmcnt(3)
    s_barrier
    s_setprio 3
    v_exp_f32 v43, v43
    ds_read_b128 v[176:179], v220 offset:0
    ds_read_b128 v[180:183], v216 offset:0
    ds_read_b128 v[184:187], v228 offset:0
    v_exp_f32 v44, v44
    ds_read_b128 v[24:27], v213 offset:28672
    ds_read_b128 v[188:191], v221 offset:0
    ds_read_b128 v[192:195], v217 offset:0
    ds_read_b128 v[196:199], v229 offset:0
    v_cvt_pk_bf16_f32 v69, v42, v43
    s_waitcnt lgkmcnt(8)
    v_mfma_f32_32x32x16_bf16 v[80:95], v[28:31], v[64:67], v[80:95]
    ds_read_b64 v[22:23], v214 offset:31232
    s_add_u32 m0, s15, 139264
    s_mov_b32 s16, 36864
    s_mov_b64 exec, s[10:11]
    buffer_load_dwordx4 v206, s[64:67], s16 offen sc1 lds
    s_mov_b64 exec, -1
    v_exp_f32 v45, v45
    v_exp_f32 v46, v46
    s_waitcnt lgkmcnt(6)
    v_mfma_f32_32x32x16_bf16 v[144:159], v[180:183], v[176:179], 0
    v_cvt_pk_bf16_f32 v70, v44, v45
    v_exp_f32 v47, v47
    v_exp_f32 v48, v48
    v_cvt_pk_bf16_f32 v71, v46, v47
    s_add_u32 m0, s15, 106496
    s_mov_b64 exec, s[10:11]
    buffer_load_dwordx4 v208, s[56:59], s23 offen lds
    s_mov_b64 exec, -1
    v_exp_f32 v49, v49
    v_exp_f32 v50, v50
    v_mfma_f32_32x32x16_bf16 v[80:95], v[200:203], v[68:71], v[80:95]
    v_cvt_pk_bf16_f32 v72, v48, v49
    v_exp_f32 v51, v51
    v_exp_f32 v52, v52
    s_waitcnt lgkmcnt(5)
    v_mfma_f32_32x32x16_bf16 v[160:175], v[184:187], v[176:179], 0
    ds_read_b128 v[176:179], v222 offset:0
    ds_read_b128 v[180:183], v218 offset:0
    ds_read_b128 v[184:187], v230 offset:0
    s_add_u32 m0, s15, 112640
    s_mov_b64 exec, s[10:11]
    buffer_load_dwordx4 v208, s[60:63], s23 offen lds
    s_mov_b64 exec, -1
    s_add_u32 s23, s23, 128
    s_cmp_eq_u32 s23, 1280
    s_cselect_b32 s23, 0, s23
    v_cvt_pk_bf16_f32 v73, v50, v51
    v_exp_f32 v53, v53
    v_exp_f32 v54, v54
    s_waitcnt lgkmcnt(7)
    v_mfma_f32_32x32x16_bf16 v[32:47], v[24:27], v[8:11], 0
    s_setprio 2
    v_cvt_pk_bf16_f32 v74, v52, v53
    v_exp_f32 v55, v55
    s_waitcnt lgkmcnt(5)
    v_mfma_f32_32x32x16_bf16 v[144:159], v[192:195], v[188:191], v[144:159]
    s_add_u32 m0, s15, 118784
    s_mov_b64 exec, s[10:11]
    buffer_load_dwordx4 v208, s[56:59], s23 offen lds
    s_mov_b64 exec, -1
    v_exp_f32 v56, v56
    v_cvt_pk_bf16_f32 v75, v54, v55
    v_exp_f32 v57, v57
    s_waitcnt lgkmcnt(3)
    v_mfma_f32_32x32x8_bf16 v[32:47], v[22:23], v[12:13], v[32:47]
    v_exp_f32 v58, v58
    v_cvt_pk_bf16_f32 v76, v56, v57
    s_add_u32 m0, s15, 124928
    s_mov_b64 exec, s[10:11]
    buffer_load_dwordx4 v208, s[60:63], s23 offen lds
    s_mov_b64 exec, -1
    s_add_u32 s23, s23, 128
    s_cmp_eq_u32 s23, 1280
    s_cselect_b32 s23, 0, s23
    v_exp_f32 v59, v59
    v_exp_f32 v60, v60
    v_cvt_pk_bf16_f32 v77, v58, v59
    v_mfma_f32_32x32x16_bf16 v[96:111], v[28:31], v[72:75], v[96:111]
    v_exp_f32 v61, v61
    ds_read_b128 v[28:31], v215 offset:29696
    v_exp_f32 v62, v62
    v_mfma_f32_32x32x16_bf16 v[160:175], v[196:199], v[188:191], v[160:175]
    ds_read_b128 v[196:199], v231 offset:0
    ds_read_b128 v[188:191], v223 offset:0
    ds_read_b128 v[192:195], v219 offset:0
    v_cvt_pk_bf16_f32 v78, v60, v61
    v_exp_f32 v63, v63
    v_exp_f32 v32, v32
    v_cvt_pk_bf16_f32 v79, v62, v63
    v_exp_f32 v33, v33
    v_exp_f32 v34, v34
    s_setprio 1
    v_mfma_f32_32x32x16_bf16 v[96:111], v[200:203], v[76:79], v[96:111]
    v_cvt_pk_bf16_f32 v64, v32, v33
    ds_read_b128 v[200:203], v215 offset:30464
    v_exp_f32 v35, v35
    v_exp_f32 v36, v36
    s_waitcnt lgkmcnt(6)
    v_mfma_f32_32x32x16_bf16 v[144:159], v[180:183], v[176:179], v[144:159]
    v_cvt_pk_bf16_f32 v65, v34, v35
    v_exp_f32 v37, v37
    v_exp_f32 v38, v38
    v_mfma_f32_32x32x16_bf16 v[48:63], v[24:27], v[16:19], 0
    v_cvt_pk_bf16_f32 v66, v36, v37
    v_exp_f32 v39, v39
    v_exp_f32 v40, v40
    v_cvt_pk_bf16_f32 v67, v38, v39
    s_setprio 0
    s_waitcnt lgkmcnt(5)
    v_mfma_f32_32x32x16_bf16 v[160:175], v[184:187], v[176:179], v[160:175]
    v_exp_f32 v41, v41
    v_mfma_f32_32x32x8_bf16 v[48:63], v[22:23], v[20:21], v[48:63]
    v_exp_f32 v42, v42
    v_cvt_pk_bf16_f32 v68, v40, v41
    s_waitcnt vmcnt(5)
    s_barrier
    s_setprio 3
    v_exp_f32 v43, v43
    ds_read_b128 v[176:179], v220 offset:12288
    ds_read_b128 v[180:183], v216 offset:8192
    ds_read_b128 v[184:187], v228 offset:8192
    v_exp_f32 v44, v44
    ds_read_b128 v[24:27], v213 offset:34816
    v_cvt_pk_bf16_f32 v69, v42, v43
    s_waitcnt lgkmcnt(8)
    v_mfma_f32_32x32x16_bf16 v[80:95], v[28:31], v[64:67], v[80:95]
    ds_read_b64 v[22:23], v214 offset:37376
    s_add_u32 m0, s15, 145408
    s_mov_b32 s16, 43008
    s_mov_b64 exec, s[10:11]
    buffer_load_dwordx4 v206, s[64:67], s16 offen sc1 lds
    s_mov_b64 exec, -1
    v_exp_f32 v45, v45
    v_exp_f32 v46, v46
    s_waitcnt lgkmcnt(6)
    v_mfma_f32_32x32x16_bf16 v[144:159], v[192:195], v[188:191], v[144:159]
    v_cvt_pk_bf16_f32 v70, v44, v45
    v_exp_f32 v47, v47
    v_exp_f32 v48, v48
    v_cvt_pk_bf16_f32 v71, v46, v47
    v_exp_f32 v49, v49
    v_exp_f32 v50, v50
    s_waitcnt lgkmcnt(5)
    v_mfma_f32_32x32x16_bf16 v[80:95], v[200:203], v[68:71], v[80:95]
    v_cvt_pk_bf16_f32 v72, v48, v49
    v_exp_f32 v51, v51
    v_exp_f32 v52, v52
    v_mfma_f32_32x32x16_bf16 v[160:175], v[196:199], v[188:191], v[160:175]
    ds_read_b128 v[188:191], v221 offset:12288
    ds_read_b128 v[192:195], v217 offset:8192
    ds_read_b128 v[196:199], v229 offset:8192
    v_cvt_pk_bf16_f32 v73, v50, v51
    v_exp_f32 v53, v53
    v_exp_f32 v54, v54
    s_waitcnt lgkmcnt(4)
    v_mfma_f32_32x32x16_bf16 v[32:47], v[24:27], v[8:11], 0
    s_setprio 2
    v_cvt_pk_bf16_f32 v74, v52, v53
    v_exp_f32 v55, v55
    v_mfma_f32_32x32x16_bf16 v[144:159], v[180:183], v[176:179], v[144:159]
    v_exp_f32 v56, v56
    v_cvt_pk_bf16_f32 v75, v54, v55
    v_exp_f32 v57, v57
    s_waitcnt lgkmcnt(3)
    v_mfma_f32_32x32x8_bf16 v[32:47], v[22:23], v[12:13], v[32:47]
    v_exp_f32 v58, v58
    v_cvt_pk_bf16_f32 v76, v56, v57
    v_exp_f32 v59, v59
    v_exp_f32 v60, v60
    v_cvt_pk_bf16_f32 v77, v58, v59
    v_mfma_f32_32x32x16_bf16 v[96:111], v[28:31], v[72:75], v[96:111]
    v_exp_f32 v61, v61
    ds_read_b128 v[28:31], v215 offset:35840
    v_exp_f32 v62, v62
    v_mfma_f32_32x32x16_bf16 v[160:175], v[184:187], v[176:179], v[160:175]
    ds_read_b128 v[176:179], v222 offset:12288
    ds_read_b128 v[180:183], v218 offset:8192
    ds_read_b128 v[184:187], v230 offset:8192
    v_cvt_pk_bf16_f32 v78, v60, v61
    v_exp_f32 v63, v63
    v_exp_f32 v32, v32
    v_cvt_pk_bf16_f32 v79, v62, v63
    v_exp_f32 v33, v33
    v_exp_f32 v34, v34
    s_setprio 1
    v_mfma_f32_32x32x16_bf16 v[96:111], v[200:203], v[76:79], v[96:111]
    v_cvt_pk_bf16_f32 v64, v32, v33
    ds_read_b128 v[200:203], v215 offset:36608
    v_exp_f32 v35, v35
    v_exp_f32 v36, v36
    s_waitcnt lgkmcnt(6)
    v_mfma_f32_32x32x16_bf16 v[144:159], v[192:195], v[188:191], v[144:159]
    v_cvt_pk_bf16_f32 v65, v34, v35
    v_exp_f32 v37, v37
    v_exp_f32 v38, v38
    v_mfma_f32_32x32x16_bf16 v[48:63], v[24:27], v[16:19], 0
    v_cvt_pk_bf16_f32 v66, v36, v37
    v_exp_f32 v39, v39
    v_exp_f32 v40, v40
    v_cvt_pk_bf16_f32 v67, v38, v39
    s_setprio 0
    s_waitcnt lgkmcnt(5)
    v_mfma_f32_32x32x16_bf16 v[160:175], v[196:199], v[188:191], v[160:175]
    ds_read_b128 v[196:199], v231 offset:8192
    ds_read_b128 v[188:191], v223 offset:12288
    ds_read_b128 v[192:195], v219 offset:8192
    v_exp_f32 v41, v41
    v_mfma_f32_32x32x8_bf16 v[48:63], v[22:23], v[20:21], v[48:63]
    v_exp_f32 v42, v42
    v_cvt_pk_bf16_f32 v68, v40, v41
    s_waitcnt vmcnt(1) lgkmcnt(0)
    s_barrier
    s_setprio 3
    v_exp_f32 v43, v43
    v_exp_f32 v44, v44
    ds_read_b128 v[24:27], v213 offset:10240
    v_cvt_pk_bf16_f32 v69, v42, v43
    v_mfma_f32_32x32x16_bf16 v[80:95], v[28:31], v[64:67], v[80:95]
    ds_read_b64 v[22:23], v214 offset:12800
    s_add_u32 m0, s15, 151552
    s_mov_b32 s16, 49152
    s_mov_b64 exec, s[10:11]
    buffer_load_dwordx4 v206, s[64:67], s16 offen sc1 lds
    s_mov_b64 exec, -1
    v_exp_f32 v45, v45
    v_exp_f32 v46, v46
    v_mfma_f32_32x32x16_bf16 v[144:159], v[180:183], v[176:179], v[144:159]
    v_mul_u32_u24 v253, 25600, v1
    v_cvt_pk_bf16_f32 v70, v44, v45
    v_exp_f32 v47, v47
    v_exp_f32 v48, v48
    v_cvt_pk_bf16_f32 v71, v46, v47
    v_exp_f32 v49, v49
    v_exp_f32 v50, v50
    v_mfma_f32_32x32x16_bf16 v[80:95], v[200:203], v[68:71], v[80:95]
    v_cvt_pk_bf16_f32 v72, v48, v49
    v_lshl_add_u32 v253, v2, 3, v253
    s_add_u32 m0, s15, 81920
    s_mov_b64 exec, s[10:11]
    buffer_load_dwordx4 v208, s[56:59], s23 offen lds
    s_mov_b64 exec, -1
    v_exp_f32 v51, v51
    v_exp_f32 v52, v52
    v_mfma_f32_32x32x16_bf16 v[160:175], v[184:187], v[176:179], v[160:175]
    ds_read_b128 v[176:179], v220 offset:24576
    ds_read_b128 v[180:183], v216 offset:16384
    ds_read_b128 v[184:187], v228 offset:16384
    v_cvt_pk_bf16_f32 v73, v50, v51
    v_exp_f32 v53, v53
    v_exp_f32 v54, v54
    s_waitcnt lgkmcnt(4)
    v_mfma_f32_32x32x16_bf16 v[32:47], v[24:27], v[8:11], 0
    s_setprio 2
    v_cvt_pk_bf16_f32 v74, v52, v53
    v_exp_f32 v55, v55
    v_mfma_f32_32x32x16_bf16 v[144:159], v[192:195], v[188:191], v[144:159]
    buffer_load_dwordx2 v[112:113], v253, s[56:59], 0 offen offset:0
    v_exp_f32 v56, v56
    v_cvt_pk_bf16_f32 v75, v54, v55
    s_add_u32 m0, s15, 88064
    s_mov_b64 exec, s[10:11]
    buffer_load_dwordx4 v208, s[60:63], s23 offen lds
    s_mov_b64 exec, -1
    s_add_u32 s23, s23, 128
    s_cmp_eq_u32 s23, 1280
    s_cselect_b32 s23, 0, s23
    v_exp_f32 v57, v57
    s_waitcnt lgkmcnt(3)
    v_mfma_f32_32x32x8_bf16 v[32:47], v[22:23], v[12:13], v[32:47]
    v_exp_f32 v58, v58
    v_cvt_pk_bf16_f32 v76, v56, v57
    v_exp_f32 v59, v59
    v_exp_f32 v60, v60
    buffer_load_dwordx2 v[114:115], v253, s[56:59], 0 offen offset:16
    v_cvt_pk_bf16_f32 v77, v58, v59
    v_mfma_f32_32x32x16_bf16 v[96:111], v[28:31], v[72:75], v[96:111]
    v_exp_f32 v61, v61
    ds_read_b128 v[28:31], v215 offset:11264
    v_exp_f32 v62, v62
    v_mfma_f32_32x32x16_bf16 v[160:175], v[196:199], v[188:191], v[160:175]
    ds_read_b128 v[188:191], v221 offset:24576
    ds_read_b128 v[192:195], v217 offset:16384
    ds_read_b128 v[196:199], v229 offset:16384
    v_cvt_pk_bf16_f32 v78, v60, v61
    v_exp_f32 v63, v63
    v_exp_f32 v32, v32
    v_cvt_pk_bf16_f32 v79, v62, v63
    buffer_load_dwordx2 v[116:117], v253, s[56:59], 0 offen offset:32
    v_exp_f32 v33, v33
    v_exp_f32 v34, v34
    s_setprio 1
    v_mfma_f32_32x32x16_bf16 v[96:111], v[200:203], v[76:79], v[96:111]
    v_cvt_pk_bf16_f32 v64, v32, v33
    ds_read_b128 v[200:203], v215 offset:12032
    v_exp_f32 v35, v35
    v_exp_f32 v36, v36
    s_waitcnt lgkmcnt(6)
    v_mfma_f32_32x32x16_bf16 v[144:159], v[180:183], v[176:179], v[144:159]
    v_cvt_pk_bf16_f32 v65, v34, v35
    v_exp_f32 v37, v37
    buffer_load_dwordx2 v[118:119], v253, s[56:59], 0 offen offset:48
    v_exp_f32 v38, v38
    v_mfma_f32_32x32x16_bf16 v[48:63], v[24:27], v[16:19], 0
    v_cvt_pk_bf16_f32 v66, v36, v37
    v_exp_f32 v39, v39
    v_exp_f32 v40, v40
    v_cvt_pk_bf16_f32 v67, v38, v39
    s_setprio 0
    s_waitcnt lgkmcnt(5)
    v_mfma_f32_32x32x16_bf16 v[160:175], v[184:187], v[176:179], v[160:175]
    ds_read_b128 v[176:179], v222 offset:24576
    ds_read_b128 v[180:183], v218 offset:16384
    ds_read_b128 v[184:187], v230 offset:16384
    v_exp_f32 v41, v41
    v_mfma_f32_32x32x8_bf16 v[48:63], v[22:23], v[20:21], v[48:63]
    buffer_load_dwordx2 v[120:121], v253, s[60:63], 0 offen offset:0
    v_exp_f32 v42, v42
    v_cvt_pk_bf16_f32 v68, v40, v41
    s_setprio 3
    v_exp_f32 v43, v43
    v_exp_f32 v44, v44
    ds_read_b128 v[24:27], v213 offset:16384
    v_cvt_pk_bf16_f32 v69, v42, v43
    s_waitcnt lgkmcnt(8)
    v_mfma_f32_32x32x16_bf16 v[80:95], v[28:31], v[64:67], v[80:95]
    ds_read_b64 v[22:23], v214 offset:18944
    s_add_u32 m0, s15, 157696
    s_mov_b32 s16, 55296
    s_mov_b64 exec, s[10:11]
    buffer_load_dwordx4 v206, s[64:67], s16 offen sc1 lds
    s_mov_b64 exec, -1
    v_exp_f32 v45, v45
    buffer_load_dwordx2 v[122:123], v253, s[60:63], 0 offen offset:16
    v_exp_f32 v46, v46
    s_waitcnt lgkmcnt(7)
    v_mfma_f32_32x32x16_bf16 v[144:159], v[192:195], v[188:191], v[144:159]
    v_cvt_pk_bf16_f32 v70, v44, v45
    v_exp_f32 v47, v47
    v_exp_f32 v48, v48
    v_cvt_pk_bf16_f32 v71, v46, v47
    v_exp_f32 v49, v49
    v_exp_f32 v50, v50
    s_waitcnt lgkmcnt(5)
    v_mfma_f32_32x32x16_bf16 v[80:95], v[200:203], v[68:71], v[80:95]
    buffer_load_dwordx2 v[124:125], v253, s[60:63], 0 offen offset:32
    v_cvt_pk_bf16_f32 v72, v48, v49
    v_exp_f32 v51, v51
    v_exp_f32 v52, v52
    v_mfma_f32_32x32x16_bf16 v[160:175], v[196:199], v[188:191], v[160:175]
    ds_read_b128 v[196:199], v231 offset:16384
    ds_read_b128 v[188:191], v223 offset:24576
    ds_read_b128 v[192:195], v219 offset:16384
    v_cvt_pk_bf16_f32 v73, v50, v51
    v_exp_f32 v53, v53
    v_exp_f32 v54, v54
    s_waitcnt lgkmcnt(4)
    v_mfma_f32_32x32x16_bf16 v[32:47], v[24:27], v[8:11], 0
    s_setprio 2
    v_cvt_pk_bf16_f32 v74, v52, v53
    buffer_load_dwordx2 v[126:127], v253, s[60:63], 0 offen offset:48
    v_exp_f32 v55, v55
    v_mfma_f32_32x32x16_bf16 v[144:159], v[180:183], v[176:179], v[144:159]
    v_exp_f32 v56, v56
    v_cvt_pk_bf16_f32 v75, v54, v55
    v_exp_f32 v57, v57
    s_waitcnt lgkmcnt(3)
    v_mfma_f32_32x32x8_bf16 v[32:47], v[22:23], v[12:13], v[32:47]
    v_exp_f32 v58, v58
    v_cvt_pk_bf16_f32 v76, v56, v57
    v_exp_f32 v59, v59
    s_mul_i32 s98, s94, 3
    v_exp_f32 v60, v60
    v_cvt_pk_bf16_f32 v77, v58, v59
    v_mfma_f32_32x32x16_bf16 v[96:111], v[28:31], v[72:75], v[96:111]
    v_exp_f32 v61, v61
    ds_read_b128 v[28:31], v215 offset:17408
    v_exp_f32 v62, v62
    v_mfma_f32_32x32x16_bf16 v[160:175], v[184:187], v[176:179], v[160:175]
    ds_read_b128 v[176:179], v220 offset:36864
    ds_read_b128 v[180:183], v216 offset:24576
    ds_read_b128 v[184:187], v228 offset:24576
    v_cvt_pk_bf16_f32 v78, v60, v61
    v_exp_f32 v63, v63
    v_exp_f32 v32, v32
    s_add_u32 s98, s98, s97
    v_cvt_pk_bf16_f32 v79, v62, v63
    v_exp_f32 v33, v33
    v_exp_f32 v34, v34
    s_setprio 1
    v_mfma_f32_32x32x16_bf16 v[96:111], v[200:203], v[76:79], v[96:111]
    v_cvt_pk_bf16_f32 v64, v32, v33
    ds_read_b128 v[200:203], v215 offset:18176
    v_exp_f32 v35, v35
    v_exp_f32 v36, v36
    s_waitcnt lgkmcnt(5)
    v_mfma_f32_32x32x16_bf16 v[144:159], v[192:195], v[188:191], v[144:159]
    v_cvt_pk_bf16_f32 v65, v34, v35
    s_lshl_b32 s98, s98, 6
    v_exp_f32 v37, v37
    v_exp_f32 v38, v38
    v_mfma_f32_32x32x16_bf16 v[48:63], v[24:27], v[16:19], 0
    v_cvt_pk_bf16_f32 v66, v36, v37
    v_exp_f32 v39, v39
    v_exp_f32 v40, v40
    v_cvt_pk_bf16_f32 v67, v38, v39
    s_setprio 0
    v_mfma_f32_32x32x16_bf16 v[160:175], v[196:199], v[188:191], v[160:175]
    ds_read_b128 v[188:191], v221 offset:36864
    ds_read_b128 v[192:195], v217 offset:24576
    ds_read_b128 v[196:199], v229 offset:24576
    v_exp_f32 v41, v41
    s_mul_i32 s99, s93, 1536
    v_mfma_f32_32x32x8_bf16 v[48:63], v[22:23], v[20:21], v[48:63]
    v_exp_f32 v42, v42
    v_cvt_pk_bf16_f32 v68, v40, v41
    s_waitcnt vmcnt(8) lgkmcnt(0)
    s_barrier
    s_setprio 3
    v_exp_f32 v43, v43
    v_exp_f32 v44, v44
    ds_read_b128 v[24:27], v213 offset:22528
    v_cvt_pk_bf16_f32 v69, v42, v43
    v_mfma_f32_32x32x16_bf16 v[80:95], v[28:31], v[64:67], v[80:95]
    ds_read_b64 v[22:23], v214 offset:25088
    s_add_u32 s98, s98, s99
    s_add_u32 m0, s15, 133120
    s_mov_b32 s16, 61440
    s_mov_b64 exec, s[10:11]
    buffer_load_dwordx4 v206, s[64:67], s16 offen sc1 lds
    s_mov_b64 exec, -1
    v_exp_f32 v45, v45
    v_exp_f32 v46, v46
    v_mfma_f32_32x32x16_bf16 v[144:159], v[180:183], v[176:179], v[144:159]
    v_cvt_pk_bf16_f32 v70, v44, v45
    v_exp_f32 v47, v47
    v_exp_f32 v48, v48
    v_cvt_pk_bf16_f32 v71, v46, v47
    s_add_u32 m0, s15, 94208
    s_mov_b64 exec, s[10:11]
    buffer_load_dwordx4 v208, s[56:59], s23 offen lds
    s_mov_b64 exec, -1
    v_exp_f32 v49, v49
    v_exp_f32 v50, v50
    s_add_u32 s98, s98, 1048576
    v_mfma_f32_32x32x16_bf16 v[80:95], v[200:203], v[68:71], v[80:95]
    v_cvt_pk_bf16_f32 v72, v48, v49
    v_exp_f32 v51, v51
    v_exp_f32 v52, v52
    v_mfma_f32_32x32x16_bf16 v[160:175], v[184:187], v[176:179], v[160:175]
    ds_read_b128 v[176:179], v222 offset:36864
    ds_read_b128 v[180:183], v218 offset:24576
    ds_read_b128 v[184:187], v230 offset:24576
    s_add_u32 m0, s15, 100352
    s_mov_b64 exec, s[10:11]
    buffer_load_dwordx4 v208, s[60:63], s23 offen lds
    s_mov_b64 exec, -1
    s_add_u32 s23, s23, 128
    s_cmp_eq_u32 s23, 1280
    s_cselect_b32 s23, 0, s23
    v_cvt_pk_bf16_f32 v73, v50, v51
    v_exp_f32 v53, v53
    v_exp_f32 v54, v54
    s_waitcnt lgkmcnt(4)
    v_mfma_f32_32x32x16_bf16 v[32:47], v[24:27], v[8:11], 0
    s_setprio 2
    v_mul_u32_u24 v253, 98304, v3
    v_cvt_pk_bf16_f32 v74, v52, v53
    v_exp_f32 v55, v55
    v_mfma_f32_32x32x16_bf16 v[144:159], v[192:195], v[188:191], v[144:159]
    s_add_u32 m0, s15, 106496
    s_mov_b64 exec, s[10:11]
    buffer_load_dwordx4 v208, s[56:59], s23 offen lds
    s_mov_b64 exec, -1
    v_exp_f32 v56, v56
    v_cvt_pk_bf16_f32 v75, v54, v55
    v_exp_f32 v57, v57
    s_waitcnt lgkmcnt(3)
    v_mfma_f32_32x32x8_bf16 v[32:47], v[22:23], v[12:13], v[32:47]
    v_exp_f32 v58, v58
    v_cvt_pk_bf16_f32 v76, v56, v57
    v_and_b32 v252, 16, v0
    s_add_u32 m0, s15, 112640
    s_mov_b64 exec, s[10:11]
    buffer_load_dwordx4 v208, s[60:63], s23 offen lds
    s_mov_b64 exec, -1
    s_add_u32 s23, s23, 128
    s_cmp_eq_u32 s23, 1280
    s_cselect_b32 s23, 0, s23
    v_exp_f32 v59, v59
    v_exp_f32 v60, v60
    v_cvt_pk_bf16_f32 v77, v58, v59
    v_mfma_f32_32x32x16_bf16 v[96:111], v[28:31], v[72:75], v[96:111]
    v_exp_f32 v61, v61
    ds_read_b128 v[28:31], v215 offset:23552
    v_exp_f32 v62, v62
    v_mfma_f32_32x32x16_bf16 v[160:175], v[196:199], v[188:191], v[160:175]
    ds_read_b128 v[196:199], v231 offset:24576
    ds_read_b128 v[188:191], v223 offset:36864
    ds_read_b128 v[192:195], v219 offset:24576
    v_cvt_pk_bf16_f32 v78, v60, v61
    v_exp_f32 v63, v63
    v_lshl_add_u32 v253, v2, 4, v253
    v_exp_f32 v32, v32
    v_cvt_pk_bf16_f32 v79, v62, v63
    v_exp_f32 v33, v33
    v_exp_f32 v34, v34
    s_setprio 1
    v_mfma_f32_32x32x16_bf16 v[96:111], v[200:203], v[76:79], v[96:111]
    v_cvt_pk_bf16_f32 v64, v32, v33
    ds_read_b128 v[200:203], v215 offset:24320
    v_exp_f32 v35, v35
    v_exp_f32 v36, v36
    s_waitcnt lgkmcnt(6)
    v_mfma_f32_32x32x16_bf16 v[144:159], v[180:183], v[176:179], v[144:159]
    v_lshl_add_u32 v253, v252, 1, v253
    v_cvt_pk_bf16_f32 v65, v34, v35
    v_exp_f32 v37, v37
    v_exp_f32 v38, v38
    v_mfma_f32_32x32x16_bf16 v[48:63], v[24:27], v[16:19], 0
    v_cvt_pk_bf16_f32 v66, v36, v37
    v_exp_f32 v39, v39
    v_exp_f32 v40, v40
    v_cvt_pk_bf16_f32 v67, v38, v39
    s_setprio 0
    s_waitcnt lgkmcnt(5)
    v_mfma_f32_32x32x16_bf16 v[160:175], v[184:187], v[176:179], v[160:175]
    ds_read_b128 v[176:179], v220 offset:0
    ds_read_b128 v[180:183], v216 offset:32768
    ds_read_b128 v[184:187], v228 offset:32768
    v_exp_f32 v41, v41
    v_mfma_f32_32x32x8_bf16 v[48:63], v[22:23], v[20:21], v[48:63]
    v_exp_f32 v42, v42
    v_cvt_pk_bf16_f32 v68, v40, v41
    s_setprio 3
    v_exp_f32 v43, v43
    v_exp_f32 v44, v44
    ds_read_b128 v[24:27], v213 offset:28672
    v_cvt_pk_bf16_f32 v69, v42, v43
    s_waitcnt lgkmcnt(8)
    v_mfma_f32_32x32x16_bf16 v[80:95], v[28:31], v[64:67], v[80:95]
    ds_read_b64 v[22:23], v214 offset:31232
    s_add_u32 m0, s15, 139264
    s_mov_b32 s16, 67584
    s_mov_b64 exec, s[10:11]
    buffer_load_dwordx4 v206, s[64:67], s16 offen sc1 lds
    s_mov_b64 exec, -1
    v_exp_f32 v45, v45
    v_exp_f32 v46, v46
    s_waitcnt lgkmcnt(6)
    v_mfma_f32_32x32x16_bf16 v[144:159], v[192:195], v[188:191], v[144:159]
    v_cvt_pk_bf16_f32 v70, v44, v45
    v_exp_f32 v47, v47
    v_exp_f32 v48, v48
    v_cvt_pk_bf16_f32 v71, v46, v47
    v_exp_f32 v49, v49
    v_exp_f32 v50, v50
    s_waitcnt lgkmcnt(5)
    v_mfma_f32_32x32x16_bf16 v[80:95], v[200:203], v[68:71], v[80:95]
    v_cvt_pk_bf16_f32 v72, v48, v49
    v_exp_f32 v51, v51
    v_exp_f32 v52, v52
    v_mfma_f32_32x32x16_bf16 v[160:175], v[196:199], v[188:191], v[160:175]
    ds_read_b128 v[188:191], v221 offset:0
    ds_read_b128 v[192:195], v217 offset:32768
    ds_read_b128 v[196:199], v229 offset:32768
    v_cvt_pk_bf16_f32 v73, v50, v51
    v_exp_f32 v53, v53
    v_exp_f32 v54, v54
    s_waitcnt lgkmcnt(4)
    v_mfma_f32_32x32x16_bf16 v[32:47], v[24:27], v[8:11], 0
    s_setprio 2
    v_cvt_pk_bf16_f32 v74, v52, v53
    v_exp_f32 v55, v55
    v_mfma_f32_32x32x16_bf16 v[144:159], v[180:183], v[176:179], v[144:159]
    v_exp_f32 v56, v56
    v_cvt_pk_bf16_f32 v75, v54, v55
    v_exp_f32 v57, v57
    s_waitcnt lgkmcnt(3)
    v_mfma_f32_32x32x8_bf16 v[32:47], v[22:23], v[12:13], v[32:47]
    v_exp_f32 v58, v58
    v_cvt_pk_bf16_f32 v76, v56, v57
    v_exp_f32 v59, v59
    v_exp_f32 v60, v60
    v_cvt_pk_bf16_f32 v77, v58, v59
    v_mfma_f32_32x32x16_bf16 v[96:111], v[28:31], v[72:75], v[96:111]
    v_exp_f32 v61, v61
    ds_read_b128 v[28:31], v215 offset:29696
    v_exp_f32 v62, v62
    v_mfma_f32_32x32x16_bf16 v[160:175], v[184:187], v[176:179], v[160:175]
    ds_read_b128 v[176:179], v222 offset:0
    ds_read_b128 v[180:183], v218 offset:32768
    ds_read_b128 v[184:187], v230 offset:32768
    v_cvt_pk_bf16_f32 v78, v60, v61
    v_exp_f32 v63, v63
    v_exp_f32 v32, v32
    v_cvt_pk_bf16_f32 v79, v62, v63
    v_exp_f32 v33, v33
    v_exp_f32 v34, v34
    s_setprio 1
    v_mfma_f32_32x32x16_bf16 v[96:111], v[200:203], v[76:79], v[96:111]
    v_cvt_pk_bf16_f32 v64, v32, v33
    ds_read_b128 v[200:203], v215 offset:30464
    v_exp_f32 v35, v35
    v_exp_f32 v36, v36
    s_waitcnt lgkmcnt(6)
    v_mfma_f32_32x32x16_bf16 v[144:159], v[192:195], v[188:191], v[144:159]
    v_cvt_pk_bf16_f32 v65, v34, v35
    v_exp_f32 v37, v37
    v_exp_f32 v38, v38
    v_mfma_f32_32x32x16_bf16 v[48:63], v[24:27], v[16:19], 0
    v_cvt_pk_bf16_f32 v66, v36, v37
    v_exp_f32 v39, v39
    v_exp_f32 v40, v40
    v_cvt_pk_bf16_f32 v67, v38, v39
    s_setprio 0
    s_waitcnt lgkmcnt(5)
    v_mfma_f32_32x32x16_bf16 v[160:175], v[196:199], v[188:191], v[160:175]
    ds_read_b128 v[196:199], v231 offset:32768
    ds_read_b128 v[188:191], v223 offset:0
    ds_read_b128 v[192:195], v219 offset:32768
    v_exp_f32 v41, v41
    v_mfma_f32_32x32x8_bf16 v[48:63], v[22:23], v[20:21], v[48:63]
    v_exp_f32 v42, v42
    v_cvt_pk_bf16_f32 v68, v40, v41
    s_waitcnt vmcnt(1) lgkmcnt(0)
    s_barrier
    s_setprio 3
    v_exp_f32 v43, v43
    v_exp_f32 v44, v44
    ds_read_b128 v[24:27], v213 offset:34816
    v_cvt_pk_bf16_f32 v69, v42, v43
    v_mfma_f32_32x32x16_bf16 v[80:95], v[28:31], v[64:67], v[80:95]
    ds_read_b64 v[22:23], v214 offset:37376
    s_add_u32 m0, s15, 145408
    s_mov_b32 s16, 73728
    s_mov_b64 exec, s[10:11]
    buffer_load_dwordx4 v206, s[64:67], s16 offen sc1 lds
    s_mov_b64 exec, -1
    v_exp_f32 v45, v45
    v_exp_f32 v46, v46
    v_mfma_f32_32x32x16_bf16 v[144:159], v[180:183], v[176:179], v[144:159]
    v_cvt_pk_bf16_f32 v70, v44, v45
    v_exp_f32 v47, v47
    v_exp_f32 v48, v48
    v_cvt_pk_bf16_f32 v71, v46, v47
    v_exp_f32 v49, v49
    v_exp_f32 v50, v50
    v_mfma_f32_32x32x16_bf16 v[80:95], v[200:203], v[68:71], v[80:95]
    v_cvt_pk_bf16_f32 v72, v48, v49
    s_add_u32 m0, s15, 118784
    s_mov_b64 exec, s[10:11]
    buffer_load_dwordx4 v208, s[56:59], s23 offen lds
    s_mov_b64 exec, -1
    v_exp_f32 v51, v51
    v_exp_f32 v52, v52
    v_mfma_f32_32x32x16_bf16 v[160:175], v[184:187], v[176:179], v[160:175]
    ds_read_b128 v[176:179], v220 offset:12288
    ds_read_b128 v[180:183], v216 offset:40960
    ds_read_b128 v[184:187], v228 offset:40960
    v_cvt_pk_bf16_f32 v73, v50, v51
    v_exp_f32 v53, v53
    v_exp_f32 v54, v54
    s_waitcnt lgkmcnt(4)
    v_mfma_f32_32x32x16_bf16 v[32:47], v[24:27], v[8:11], 0
    s_setprio 2
    v_cvt_pk_bf16_f32 v74, v52, v53
    v_exp_f32 v55, v55
    v_mfma_f32_32x32x16_bf16 v[144:159], v[192:195], v[188:191], v[144:159]
    v_exp_f32 v56, v56
    v_cvt_pk_bf16_f32 v75, v54, v55
    s_add_u32 m0, s15, 124928
    s_mov_b64 exec, s[10:11]
    buffer_load_dwordx4 v208, s[60:63], s23 offen lds
    s_mov_b64 exec, -1
    s_add_u32 s23, s23, 128
    s_cmp_eq_u32 s23, 1280
    s_cselect_b32 s23, 0, s23
    v_exp_f32 v57, v57
    s_waitcnt lgkmcnt(3)
    v_mfma_f32_32x32x8_bf16 v[32:47], v[22:23], v[12:13], v[32:47]
    v_exp_f32 v58, v58
    v_cvt_pk_bf16_f32 v76, v56, v57
    v_exp_f32 v59, v59
    v_exp_f32 v60, v60
    v_cvt_pk_bf16_f32 v77, v58, v59
    v_mfma_f32_32x32x16_bf16 v[96:111], v[28:31], v[72:75], v[96:111]
    v_exp_f32 v61, v61
    ds_read_b128 v[28:31], v215 offset:35840
    v_exp_f32 v62, v62
    v_mfma_f32_32x32x16_bf16 v[160:175], v[196:199], v[188:191], v[160:175]
    ds_read_b128 v[188:191], v221 offset:12288
    ds_read_b128 v[192:195], v217 offset:40960
    ds_read_b128 v[196:199], v229 offset:40960
    v_cvt_pk_bf16_f32 v78, v60, v61
    v_exp_f32 v63, v63
    v_exp_f32 v32, v32
    v_cvt_pk_bf16_f32 v79, v62, v63
    v_exp_f32 v33, v33
    v_exp_f32 v34, v34
    s_setprio 1
    v_mfma_f32_32x32x16_bf16 v[96:111], v[200:203], v[76:79], v[96:111]
    v_cvt_pk_bf16_f32 v64, v32, v33
    ds_read_b128 v[200:203], v215 offset:36608
    v_exp_f32 v35, v35
    v_exp_f32 v36, v36
    s_waitcnt lgkmcnt(6)
    v_mfma_f32_32x32x16_bf16 v[144:159], v[180:183], v[176:179], v[144:159]
    v_cvt_pk_bf16_f32 v65, v34, v35
    v_exp_f32 v37, v37
    v_exp_f32 v38, v38
    v_mfma_f32_32x32x16_bf16 v[48:63], v[24:27], v[16:19], 0
    v_cvt_pk_bf16_f32 v66, v36, v37
    v_exp_f32 v39, v39
    v_exp_f32 v40, v40
    v_cvt_pk_bf16_f32 v67, v38, v39
    s_setprio 0
    s_waitcnt lgkmcnt(5)
    v_mfma_f32_32x32x16_bf16 v[160:175], v[184:187], v[176:179], v[160:175]
    ds_read_b128 v[176:179], v222 offset:12288
    ds_read_b128 v[180:183], v218 offset:40960
    ds_read_b128 v[184:187], v230 offset:40960
    v_exp_f32 v41, v41
    v_mfma_f32_32x32x8_bf16 v[48:63], v[22:23], v[20:21], v[48:63]
    v_exp_f32 v42, v42
    v_cvt_pk_bf16_f32 v68, v40, v41
    s_setprio 3
    v_exp_f32 v43, v43
    v_exp_f32 v44, v44
    ds_read_b128 v[24:27], v213 offset:10240
    v_cvt_pk_bf16_f32 v69, v42, v43
    s_waitcnt lgkmcnt(8)
    v_mfma_f32_32x32x16_bf16 v[80:95], v[28:31], v[64:67], v[80:95]
    ds_read_b64 v[22:23], v214 offset:12800
    s_add_u32 m0, s15, 151552
    s_mov_b32 s16, 79872
    s_mov_b64 exec, s[10:11]
    buffer_load_dwordx4 v206, s[64:67], s16 offen sc1 lds
    s_mov_b64 exec, -1
    v_exp_f32 v45, v45
    v_exp_f32 v46, v46
    s_waitcnt lgkmcnt(7)
    v_mfma_f32_32x32x16_bf16 v[144:159], v[192:195], v[188:191], v[144:159]
    v_cvt_pk_bf16_f32 v70, v44, v45
    v_exp_f32 v47, v47
    v_exp_f32 v48, v48
    v_cvt_pk_bf16_f32 v71, v46, v47
    v_exp_f32 v49, v49
    v_exp_f32 v50, v50
    s_waitcnt lgkmcnt(5)
    v_mfma_f32_32x32x16_bf16 v[80:95], v[200:203], v[68:71], v[80:95]
    v_cvt_pk_bf16_f32 v72, v48, v49
    v_exp_f32 v51, v51
    v_exp_f32 v52, v52
    v_mfma_f32_32x32x16_bf16 v[160:175], v[196:199], v[188:191], v[160:175]
    ds_read_b128 v[196:199], v231 offset:40960
    ds_read_b128 v[188:191], v223 offset:12288
    ds_read_b128 v[192:195], v219 offset:40960
    v_cvt_pk_bf16_f32 v73, v50, v51
    v_exp_f32 v53, v53
    v_exp_f32 v54, v54
    v_mov_b32 v240, -1
    v_mov_b32 v241, -1
    v_mov_b32 v242, -1
    v_mov_b32 v243, -1
    buffer_store_dwordx4 v[240:243], v14, s[64:67], 0 offen sc1
    s_mov_b32 exec_hi, 0
    buffer_store_dwordx2 v[240:241], v15, s[64:67], 0 offen sc1
    s_mov_b32 exec_hi, -1
    s_waitcnt lgkmcnt(4)
    v_mfma_f32_32x32x16_bf16 v[32:47], v[24:27], v[8:11], 0
    s_setprio 2
    v_cvt_pk_bf16_f32 v74, v52, v53
    v_exp_f32 v55, v55
    v_mfma_f32_32x32x16_bf16 v[144:159], v[180:183], v[176:179], v[144:159]
    v_exp_f32 v56, v56
    v_cvt_pk_bf16_f32 v75, v54, v55
    v_exp_f32 v57, v57
    s_waitcnt lgkmcnt(3)
    v_mfma_f32_32x32x8_bf16 v[32:47], v[22:23], v[12:13], v[32:47]
    v_exp_f32 v58, v58
    v_cvt_pk_bf16_f32 v76, v56, v57
    v_exp_f32 v59, v59
    v_exp_f32 v60, v60
    v_cvt_pk_bf16_f32 v77, v58, v59
    v_mfma_f32_32x32x16_bf16 v[96:111], v[28:31], v[72:75], v[96:111]
    v_exp_f32 v61, v61
    ds_read_b128 v[28:31], v215 offset:11264
    v_exp_f32 v62, v62
    v_mfma_f32_32x32x16_bf16 v[160:175], v[184:187], v[176:179], v[160:175]
    ds_read_b128 v[176:179], v220 offset:24576
    ds_read_b128 v[180:183], v216 offset:49152
    ds_read_b128 v[184:187], v228 offset:49152
    v_cvt_pk_bf16_f32 v78, v60, v61
    v_exp_f32 v63, v63
    v_exp_f32 v32, v32
    v_cvt_pk_bf16_f32 v79, v62, v63
    v_exp_f32 v33, v33
    v_exp_f32 v34, v34
    s_setprio 1
    v_mfma_f32_32x32x16_bf16 v[96:111], v[200:203], v[76:79], v[96:111]
    v_cvt_pk_bf16_f32 v64, v32, v33
    ds_read_b128 v[200:203], v215 offset:12032
    v_exp_f32 v35, v35
    v_exp_f32 v36, v36
    s_waitcnt lgkmcnt(5)
    v_mfma_f32_32x32x16_bf16 v[144:159], v[192:195], v[188:191], v[144:159]
    v_cvt_pk_bf16_f32 v65, v34, v35
    v_exp_f32 v37, v37
    v_exp_f32 v38, v38
    v_mfma_f32_32x32x16_bf16 v[48:63], v[24:27], v[16:19], 0
    v_cvt_pk_bf16_f32 v66, v36, v37
    v_exp_f32 v39, v39
    v_exp_f32 v40, v40
    v_cvt_pk_bf16_f32 v67, v38, v39
    s_setprio 0
    v_mfma_f32_32x32x16_bf16 v[160:175], v[196:199], v[188:191], v[160:175]
    ds_read_b128 v[188:191], v221 offset:24576
    ds_read_b128 v[192:195], v217 offset:49152
    ds_read_b128 v[196:199], v229 offset:49152
    v_exp_f32 v41, v41
    v_mfma_f32_32x32x8_bf16 v[48:63], v[22:23], v[20:21], v[48:63]
    v_exp_f32 v42, v42
    v_cvt_pk_bf16_f32 v68, v40, v41
    s_waitcnt vmcnt(3) lgkmcnt(0)
    s_barrier
    s_setprio 3
    v_exp_f32 v43, v43
    v_exp_f32 v44, v44
    ds_read_b128 v[24:27], v213 offset:16384
    v_cvt_pk_bf16_f32 v69, v42, v43
    v_mfma_f32_32x32x16_bf16 v[80:95], v[28:31], v[64:67], v[80:95]
    ds_read_b64 v[22:23], v214 offset:18944
    s_add_u32 m0, s15, 157696
    s_mov_b32 s16, 86016
    s_mov_b64 exec, s[10:11]
    buffer_load_dwordx4 v206, s[64:67], s16 offen sc1 lds
    s_mov_b64 exec, -1
    v_exp_f32 v45, v45
    v_exp_f32 v46, v46
    v_mfma_f32_32x32x16_bf16 v[144:159], v[180:183], v[176:179], v[144:159]
    v_cvt_pk_bf16_f32 v70, v44, v45
    v_exp_f32 v47, v47
    v_exp_f32 v48, v48
    v_cvt_pk_bf16_f32 v71, v46, v47
    s_add_u32 m0, s15, 81920
    s_mov_b64 exec, s[10:11]
    buffer_load_dwordx4 v208, s[56:59], s23 offen lds
    s_mov_b64 exec, -1
    v_exp_f32 v49, v49
    v_exp_f32 v50, v50
    v_mfma_f32_32x32x16_bf16 v[80:95], v[200:203], v[68:71], v[80:95]
    v_cvt_pk_bf16_f32 v72, v48, v49
    v_exp_f32 v51, v51
    v_exp_f32 v52, v52
    v_mfma_f32_32x32x16_bf16 v[160:175], v[184:187], v[176:179], v[160:175]
    ds_read_b128 v[176:179], v222 offset:24576
    ds_read_b128 v[180:183], v218 offset:49152
    ds_read_b128 v[184:187], v230 offset:49152
    s_add_u32 m0, s15, 88064
    s_mov_b64 exec, s[10:11]
    buffer_load_dwordx4 v208, s[60:63], s23 offen lds
    s_mov_b64 exec, -1
    s_add_u32 s23, s23, 128
    s_cmp_eq_u32 s23, 1280
    s_cselect_b32 s23, 0, s23
    v_cvt_pk_bf16_f32 v73, v50, v51
    v_exp_f32 v53, v53
    v_exp_f32 v54, v54
    s_waitcnt lgkmcnt(4)
    v_mfma_f32_32x32x16_bf16 v[32:47], v[24:27], v[8:11], 0
    s_setprio 2
    v_cvt_pk_bf16_f32 v74, v52, v53
    v_exp_f32 v55, v55
    v_mfma_f32_32x32x16_bf16 v[144:159], v[192:195], v[188:191], v[144:159]
    s_add_u32 m0, s15, 94208
    s_mov_b64 exec, s[10:11]
    buffer_load_dwordx4 v208, s[56:59], s23 offen lds
    s_mov_b64 exec, -1
    v_exp_f32 v56, v56
    v_cvt_pk_bf16_f32 v75, v54, v55
    v_exp_f32 v57, v57
    s_waitcnt lgkmcnt(3)
    v_mfma_f32_32x32x8_bf16 v[32:47], v[22:23], v[12:13], v[32:47]
    v_exp_f32 v58, v58
    v_cvt_pk_bf16_f32 v76, v56, v57
    s_add_u32 m0, s15, 100352
    s_mov_b64 exec, s[10:11]
    buffer_load_dwordx4 v208, s[60:63], s23 offen lds
    s_mov_b64 exec, -1
    s_add_u32 s23, s23, 128
    s_cmp_eq_u32 s23, 1280
    s_cselect_b32 s23, 0, s23
    v_exp_f32 v59, v59
    v_exp_f32 v60, v60
    v_cvt_pk_bf16_f32 v77, v58, v59
    v_mfma_f32_32x32x16_bf16 v[96:111], v[28:31], v[72:75], v[96:111]
    v_exp_f32 v61, v61
    ds_read_b128 v[28:31], v215 offset:17408
    v_exp_f32 v62, v62
    v_mfma_f32_32x32x16_bf16 v[160:175], v[196:199], v[188:191], v[160:175]
    ds_read_b128 v[196:199], v231 offset:49152
    ds_read_b128 v[188:191], v223 offset:24576
    ds_read_b128 v[192:195], v219 offset:49152
    v_cvt_pk_bf16_f32 v78, v60, v61
    v_exp_f32 v63, v63
    v_exp_f32 v32, v32
    v_cvt_pk_bf16_f32 v79, v62, v63
    v_exp_f32 v33, v33
    v_exp_f32 v34, v34
    s_setprio 1
    v_mfma_f32_32x32x16_bf16 v[96:111], v[200:203], v[76:79], v[96:111]
    v_cvt_pk_bf16_f32 v64, v32, v33
    ds_read_b128 v[200:203], v215 offset:18176
    v_exp_f32 v35, v35
    v_exp_f32 v36, v36
    s_waitcnt lgkmcnt(6)
    v_mfma_f32_32x32x16_bf16 v[144:159], v[180:183], v[176:179], v[144:159]
    v_cvt_pk_bf16_f32 v65, v34, v35
    v_exp_f32 v37, v37
    v_exp_f32 v38, v38
    v_mfma_f32_32x32x16_bf16 v[48:63], v[24:27], v[16:19], 0
    v_cvt_pk_bf16_f32 v66, v36, v37
    v_exp_f32 v39, v39
    v_exp_f32 v40, v40
    v_cvt_pk_bf16_f32 v67, v38, v39
    s_setprio 0
    s_waitcnt lgkmcnt(5)
    v_mfma_f32_32x32x16_bf16 v[160:175], v[184:187], v[176:179], v[160:175]
    ds_read_b128 v[176:179], v220 offset:36864
    ds_read_b128 v[180:183], v216 offset:57344
    ds_read_b128 v[184:187], v228 offset:57344
    v_add_u32 v216, 0x10000, v216
    v_add_u32 v228, 0x10000, v228
    v_exp_f32 v41, v41
    v_mfma_f32_32x32x8_bf16 v[48:63], v[22:23], v[20:21], v[48:63]
    v_exp_f32 v42, v42
    v_cvt_pk_bf16_f32 v68, v40, v41
    s_setprio 3
    v_exp_f32 v43, v43
    v_exp_f32 v44, v44
    ds_read_b128 v[24:27], v213 offset:22528
    v_cvt_pk_bf16_f32 v69, v42, v43
    s_waitcnt lgkmcnt(8)
    v_mfma_f32_32x32x16_bf16 v[80:95], v[28:31], v[64:67], v[80:95]
    ds_read_b64 v[22:23], v214 offset:25088
    s_add_u32 m0, s15, 133120
    s_mov_b32 s16, 92160
    s_mov_b64 exec, s[10:11]
    buffer_load_dwordx4 v206, s[64:67], s16 offen sc1 lds
    s_mov_b64 exec, -1
    v_exp_f32 v45, v45
    v_exp_f32 v46, v46
    s_waitcnt lgkmcnt(6)
    v_mfma_f32_32x32x16_bf16 v[144:159], v[192:195], v[188:191], v[144:159]
    v_cvt_pk_bf16_f32 v70, v44, v45
    v_exp_f32 v47, v47
    v_exp_f32 v48, v48
    v_cvt_pk_bf16_f32 v71, v46, v47
    v_exp_f32 v49, v49
    v_exp_f32 v50, v50
    s_waitcnt lgkmcnt(5)
    v_mfma_f32_32x32x16_bf16 v[80:95], v[200:203], v[68:71], v[80:95]
    v_cvt_pk_bf16_f32 v72, v48, v49
    v_exp_f32 v51, v51
    v_exp_f32 v52, v52
    v_mfma_f32_32x32x16_bf16 v[160:175], v[196:199], v[188:191], v[160:175]
    ds_read_b128 v[188:191], v221 offset:36864
    ds_read_b128 v[192:195], v217 offset:57344
    ds_read_b128 v[196:199], v229 offset:57344
    v_add_u32 v217, 0x10000, v217
    v_add_u32 v229, 0x10000, v229
    v_cvt_pk_bf16_f32 v73, v50, v51
    v_exp_f32 v53, v53
    v_exp_f32 v54, v54
    s_waitcnt lgkmcnt(4)
    v_mfma_f32_32x32x16_bf16 v[32:47], v[24:27], v[8:11], 0
    s_setprio 2
    v_cvt_pk_bf16_f32 v74, v52, v53
    v_exp_f32 v55, v55
    v_mfma_f32_32x32x16_bf16 v[144:159], v[180:183], v[176:179], v[144:159]
    v_exp_f32 v56, v56
    v_cvt_pk_bf16_f32 v75, v54, v55
    v_exp_f32 v57, v57
    s_waitcnt lgkmcnt(3)
    v_mfma_f32_32x32x8_bf16 v[32:47], v[22:23], v[12:13], v[32:47]
    v_exp_f32 v58, v58
    v_cvt_pk_bf16_f32 v76, v56, v57
    v_exp_f32 v59, v59
    v_exp_f32 v60, v60
    v_cvt_pk_bf16_f32 v77, v58, v59
    v_mfma_f32_32x32x16_bf16 v[96:111], v[28:31], v[72:75], v[96:111]
    v_exp_f32 v61, v61
    ds_read_b128 v[28:31], v215 offset:23552
    v_exp_f32 v62, v62
    v_mfma_f32_32x32x16_bf16 v[160:175], v[184:187], v[176:179], v[160:175]
    ds_read_b128 v[176:179], v222 offset:36864
    ds_read_b128 v[180:183], v218 offset:57344
    ds_read_b128 v[184:187], v230 offset:57344
    v_add_u32 v218, 0x10000, v218
    v_add_u32 v230, 0x10000, v230
    v_cvt_pk_bf16_f32 v78, v60, v61
    v_exp_f32 v63, v63
    v_exp_f32 v32, v32
    v_cvt_pk_bf16_f32 v79, v62, v63
    v_exp_f32 v33, v33
    v_exp_f32 v34, v34
    s_setprio 1
    v_mfma_f32_32x32x16_bf16 v[96:111], v[200:203], v[76:79], v[96:111]
    v_cvt_pk_bf16_f32 v64, v32, v33
    ds_read_b128 v[200:203], v215 offset:24320
    v_exp_f32 v35, v35
    v_exp_f32 v36, v36
    s_waitcnt lgkmcnt(6)
    v_mfma_f32_32x32x16_bf16 v[144:159], v[192:195], v[188:191], v[144:159]
    v_cvt_pk_bf16_f32 v65, v34, v35
    v_exp_f32 v37, v37
    v_exp_f32 v38, v38
    v_mfma_f32_32x32x16_bf16 v[48:63], v[24:27], v[16:19], 0
    v_cvt_pk_bf16_f32 v66, v36, v37
    v_exp_f32 v39, v39
    v_exp_f32 v40, v40
    v_cvt_pk_bf16_f32 v67, v38, v39
    s_setprio 0
    s_waitcnt lgkmcnt(5)
    v_mfma_f32_32x32x16_bf16 v[160:175], v[196:199], v[188:191], v[160:175]
    ds_read_b128 v[196:199], v231 offset:57344
    ds_read_b128 v[188:191], v223 offset:36864
    ds_read_b128 v[192:195], v219 offset:57344
    v_add_u32 v219, 0x10000, v219
    v_add_u32 v231, 0x10000, v231
    v_exp_f32 v41, v41
    v_mfma_f32_32x32x8_bf16 v[48:63], v[22:23], v[20:21], v[48:63]
    v_exp_f32 v42, v42
    v_cvt_pk_bf16_f32 v68, v40, v41
    s_waitcnt vmcnt(1) lgkmcnt(0)
    s_barrier
    s_setprio 3
    v_exp_f32 v43, v43
    v_exp_f32 v44, v44
    ds_read_b128 v[24:27], v213 offset:28672
    v_cvt_pk_bf16_f32 v69, v42, v43
    v_mfma_f32_32x32x16_bf16 v[80:95], v[28:31], v[64:67], v[80:95]
    ds_read_b64 v[22:23], v214 offset:31232
    s_add_u32 m0, s15, 139264
    s_mov_b32 s16, 98304
    s_mov_b64 exec, s[10:11]
    buffer_load_dwordx4 v206, s[64:67], s16 offen sc1 lds
    s_mov_b64 exec, -1
    v_exp_f32 v45, v45
    v_exp_f32 v46, v46
    v_mfma_f32_32x32x16_bf16 v[144:159], v[180:183], v[176:179], v[144:159]
    v_cvt_pk_bf16_f32 v70, v44, v45
    v_exp_f32 v47, v47
    v_exp_f32 v48, v48
    v_cvt_pk_bf16_f32 v71, v46, v47
    v_exp_f32 v49, v49
    v_exp_f32 v50, v50
    v_mfma_f32_32x32x16_bf16 v[80:95], v[200:203], v[68:71], v[80:95]
    v_cvt_pk_bf16_f32 v72, v48, v49
    v_exp_f32 v51, v51
    v_exp_f32 v52, v52
    v_mfma_f32_32x32x16_bf16 v[160:175], v[184:187], v[176:179], v[160:175]
    ds_read_b128 v[176:179], v220 offset:0
    ds_read_b128 v[180:183], v216 offset:0
    ds_read_b128 v[184:187], v228 offset:0
    v_cvt_pk_bf16_f32 v73, v50, v51
    v_exp_f32 v53, v53
    v_exp_f32 v54, v54
    s_waitcnt lgkmcnt(4)
    v_mfma_f32_32x32x16_bf16 v[32:47], v[24:27], v[8:11], 0
    s_setprio 2
    v_cvt_pk_bf16_f32 v74, v52, v53
    v_exp_f32 v55, v55
    v_mfma_f32_32x32x16_bf16 v[144:159], v[192:195], v[188:191], v[144:159]
    v_exp_f32 v56, v56
    v_cvt_pk_bf16_f32 v75, v54, v55
    v_exp_f32 v57, v57
    s_waitcnt lgkmcnt(3)
    v_mfma_f32_32x32x8_bf16 v[32:47], v[22:23], v[12:13], v[32:47]
    v_exp_f32 v58, v58
    v_cvt_pk_bf16_f32 v76, v56, v57
    v_exp_f32 v59, v59
    v_exp_f32 v60, v60
    v_cvt_pk_bf16_f32 v77, v58, v59
    v_mfma_f32_32x32x16_bf16 v[96:111], v[28:31], v[72:75], v[96:111]
    v_exp_f32 v61, v61
    ds_read_b128 v[28:31], v215 offset:29696
    v_exp_f32 v62, v62
    v_mfma_f32_32x32x16_bf16 v[160:175], v[196:199], v[188:191], v[160:175]
    ds_read_b128 v[188:191], v221 offset:0
    ds_read_b128 v[192:195], v217 offset:0
    ds_read_b128 v[196:199], v229 offset:0
    v_cvt_pk_bf16_f32 v78, v60, v61
    v_exp_f32 v63, v63
    v_exp_f32 v32, v32
    v_cvt_pk_bf16_f32 v79, v62, v63
    v_exp_f32 v33, v33
    v_exp_f32 v34, v34
    s_setprio 1
    v_mfma_f32_32x32x16_bf16 v[96:111], v[200:203], v[76:79], v[96:111]
    v_cvt_pk_bf16_f32 v64, v32, v33
    ds_read_b128 v[200:203], v215 offset:30464
    v_exp_f32 v35, v35
    v_exp_f32 v36, v36
    s_waitcnt lgkmcnt(6)
    v_mfma_f32_32x32x16_bf16 v[144:159], v[180:183], v[176:179], v[144:159]
    v_cvt_pk_bf16_f32 v65, v34, v35
    v_exp_f32 v37, v37
    v_exp_f32 v38, v38
    v_mfma_f32_32x32x16_bf16 v[48:63], v[24:27], v[16:19], 0
    v_cvt_pk_bf16_f32 v66, v36, v37
    v_exp_f32 v39, v39
    v_exp_f32 v40, v40
    v_cvt_pk_bf16_f32 v67, v38, v39
    s_setprio 0
    s_waitcnt lgkmcnt(5)
    v_mfma_f32_32x32x16_bf16 v[160:175], v[184:187], v[176:179], v[160:175]
    ds_read_b128 v[176:179], v222 offset:0
    ds_read_b128 v[180:183], v218 offset:0
    ds_read_b128 v[184:187], v230 offset:0
    v_exp_f32 v41, v41
    v_mfma_f32_32x32x8_bf16 v[48:63], v[22:23], v[20:21], v[48:63]
    v_exp_f32 v42, v42
    v_cvt_pk_bf16_f32 v68, v40, v41
    s_setprio 3
    v_exp_f32 v43, v43
    v_exp_f32 v44, v44
    ds_read_b128 v[24:27], v213 offset:34816
    v_cvt_pk_bf16_f32 v69, v42, v43
    s_waitcnt lgkmcnt(8)
    v_mfma_f32_32x32x16_bf16 v[80:95], v[28:31], v[64:67], v[80:95]
    ds_read_b64 v[22:23], v214 offset:37376
    s_add_u32 m0, s15, 145408
    s_mov_b32 s16, 104448
    s_mov_b64 exec, s[10:11]
    buffer_load_dwordx4 v206, s[64:67], s16 offen sc1 lds
    s_mov_b64 exec, -1
    v_exp_f32 v45, v45
    v_exp_f32 v46, v46
    s_waitcnt lgkmcnt(7)
    v_mfma_f32_32x32x16_bf16 v[144:159], v[192:195], v[188:191], v[144:159]
    v_cvt_pk_bf16_f32 v70, v44, v45
    v_exp_f32 v47, v47
    v_exp_f32 v48, v48
    v_cvt_pk_bf16_f32 v71, v46, v47
    v_exp_f32 v49, v49
    v_exp_f32 v50, v50
    s_waitcnt lgkmcnt(5)
    v_mfma_f32_32x32x16_bf16 v[80:95], v[200:203], v[68:71], v[80:95]
    v_cvt_pk_bf16_f32 v72, v48, v49
    v_exp_f32 v51, v51
    v_exp_f32 v52, v52
    v_mfma_f32_32x32x16_bf16 v[160:175], v[196:199], v[188:191], v[160:175]
    ds_read_b128 v[196:199], v231 offset:0
    ds_read_b128 v[188:191], v223 offset:0
    ds_read_b128 v[192:195], v219 offset:0
    v_cvt_pk_bf16_f32 v73, v50, v51
    v_exp_f32 v53, v53
    v_exp_f32 v54, v54
    s_waitcnt lgkmcnt(4)
    v_mfma_f32_32x32x16_bf16 v[32:47], v[24:27], v[8:11], 0
    s_setprio 2
    v_cvt_pk_bf16_f32 v74, v52, v53
    v_exp_f32 v55, v55
    v_mfma_f32_32x32x16_bf16 v[144:159], v[180:183], v[176:179], v[144:159]
    v_exp_f32 v56, v56
    v_cvt_pk_bf16_f32 v75, v54, v55
    v_exp_f32 v57, v57
    s_waitcnt lgkmcnt(3)
    v_mfma_f32_32x32x8_bf16 v[32:47], v[22:23], v[12:13], v[32:47]
    v_exp_f32 v58, v58
    v_cvt_pk_bf16_f32 v76, v56, v57
    v_exp_f32 v59, v59
    v_exp_f32 v60, v60
    v_cvt_pk_bf16_f32 v77, v58, v59
    v_mfma_f32_32x32x16_bf16 v[96:111], v[28:31], v[72:75], v[96:111]
    v_exp_f32 v61, v61
    ds_read_b128 v[28:31], v215 offset:35840
    v_exp_f32 v62, v62
    v_mfma_f32_32x32x16_bf16 v[160:175], v[184:187], v[176:179], v[160:175]
    ds_read_b128 v[176:179], v220 offset:12288
    ds_read_b128 v[180:183], v216 offset:8192
    ds_read_b128 v[184:187], v228 offset:8192
    v_cvt_pk_bf16_f32 v78, v60, v61
    v_exp_f32 v63, v63
    v_exp_f32 v32, v32
    v_cvt_pk_bf16_f32 v79, v62, v63
    v_exp_f32 v33, v33
    v_exp_f32 v34, v34
    s_setprio 1
    v_mfma_f32_32x32x16_bf16 v[96:111], v[200:203], v[76:79], v[96:111]
    v_cvt_pk_bf16_f32 v64, v32, v33
    ds_read_b128 v[200:203], v215 offset:36608
    v_exp_f32 v35, v35
    v_exp_f32 v36, v36
    s_waitcnt lgkmcnt(5)
    v_mfma_f32_32x32x16_bf16 v[144:159], v[192:195], v[188:191], v[144:159]
    v_cvt_pk_bf16_f32 v65, v34, v35
    v_exp_f32 v37, v37
    v_exp_f32 v38, v38
    v_mfma_f32_32x32x16_bf16 v[48:63], v[24:27], v[16:19], 0
    v_cvt_pk_bf16_f32 v66, v36, v37
    v_exp_f32 v39, v39
    v_exp_f32 v40, v40
    v_cvt_pk_bf16_f32 v67, v38, v39
    s_setprio 0
    v_mfma_f32_32x32x16_bf16 v[160:175], v[196:199], v[188:191], v[160:175]
    ds_read_b128 v[188:191], v221 offset:12288
    ds_read_b128 v[192:195], v217 offset:8192
    ds_read_b128 v[196:199], v229 offset:8192
    v_exp_f32 v41, v41
    v_mfma_f32_32x32x8_bf16 v[48:63], v[22:23], v[20:21], v[48:63]
    v_exp_f32 v42, v42
    v_cvt_pk_bf16_f32 v68, v40, v41
    s_waitcnt vmcnt(1) lgkmcnt(0)
    s_barrier
    s_setprio 3
    v_exp_f32 v43, v43
    v_exp_f32 v44, v44
    ds_read_b128 v[24:27], v213 offset:10240
    v_cvt_pk_bf16_f32 v69, v42, v43
    v_mfma_f32_32x32x16_bf16 v[80:95], v[28:31], v[64:67], v[80:95]
    ds_read_b64 v[22:23], v214 offset:12800
    s_add_u32 m0, s15, 151552
    s_mov_b32 s16, 110592
    s_mov_b64 exec, s[10:11]
    buffer_load_dwordx4 v206, s[64:67], s16 offen sc1 lds
    s_mov_b64 exec, -1
    v_exp_f32 v45, v45
    v_exp_f32 v46, v46
    v_mfma_f32_32x32x16_bf16 v[144:159], v[180:183], v[176:179], v[144:159]
    v_cvt_pk_bf16_f32 v70, v44, v45
    v_exp_f32 v47, v47
    v_exp_f32 v48, v48
    v_cvt_pk_bf16_f32 v71, v46, v47
    v_exp_f32 v49, v49
    v_exp_f32 v50, v50
    v_mfma_f32_32x32x16_bf16 v[80:95], v[200:203], v[68:71], v[80:95]
    v_cvt_pk_bf16_f32 v72, v48, v49
    v_exp_f32 v51, v51
    v_exp_f32 v52, v52
    v_mfma_f32_32x32x16_bf16 v[160:175], v[184:187], v[176:179], v[160:175]
    ds_read_b128 v[176:179], v222 offset:12288
    ds_read_b128 v[180:183], v218 offset:8192
    ds_read_b128 v[184:187], v230 offset:8192
    v_cvt_pk_bf16_f32 v73, v50, v51
    v_exp_f32 v53, v53
    v_exp_f32 v54, v54
    s_waitcnt lgkmcnt(4)
    v_mfma_f32_32x32x16_bf16 v[32:47], v[24:27], v[8:11], 0
    s_setprio 2
    v_cvt_pk_bf16_f32 v74, v52, v53
    v_exp_f32 v55, v55
    v_mfma_f32_32x32x16_bf16 v[144:159], v[192:195], v[188:191], v[144:159]
    v_exp_f32 v56, v56
    v_cvt_pk_bf16_f32 v75, v54, v55
    v_exp_f32 v57, v57
    s_waitcnt lgkmcnt(3)
    v_mfma_f32_32x32x8_bf16 v[32:47], v[22:23], v[12:13], v[32:47]
    v_exp_f32 v58, v58
    v_cvt_pk_bf16_f32 v76, v56, v57
    v_exp_f32 v59, v59
    v_exp_f32 v60, v60
    v_cvt_pk_bf16_f32 v77, v58, v59
    v_mfma_f32_32x32x16_bf16 v[96:111], v[28:31], v[72:75], v[96:111]
    v_exp_f32 v61, v61
    ds_read_b128 v[28:31], v215 offset:11264
    v_exp_f32 v62, v62
    v_mfma_f32_32x32x16_bf16 v[160:175], v[196:199], v[188:191], v[160:175]
    ds_read_b128 v[196:199], v231 offset:8192
    ds_read_b128 v[188:191], v223 offset:12288
    ds_read_b128 v[192:195], v219 offset:8192
    v_cvt_pk_bf16_f32 v78, v60, v61
    v_exp_f32 v63, v63
    v_exp_f32 v32, v32
    v_cvt_pk_bf16_f32 v79, v62, v63
    v_exp_f32 v33, v33
    v_exp_f32 v34, v34
    s_setprio 1
    v_mfma_f32_32x32x16_bf16 v[96:111], v[200:203], v[76:79], v[96:111]
    v_cvt_pk_bf16_f32 v64, v32, v33
    ds_read_b128 v[200:203], v215 offset:12032
    v_exp_f32 v35, v35
    v_exp_f32 v36, v36
    s_waitcnt lgkmcnt(6)
    v_mfma_f32_32x32x16_bf16 v[144:159], v[180:183], v[176:179], v[144:159]
    v_cvt_pk_bf16_f32 v65, v34, v35
    v_exp_f32 v37, v37
    v_exp_f32 v38, v38
    v_mfma_f32_32x32x16_bf16 v[48:63], v[24:27], v[16:19], 0
    v_cvt_pk_bf16_f32 v66, v36, v37
    v_exp_f32 v39, v39
    v_exp_f32 v40, v40
    v_cvt_pk_bf16_f32 v67, v38, v39
    s_setprio 0
    s_waitcnt lgkmcnt(5)
    v_mfma_f32_32x32x16_bf16 v[160:175], v[184:187], v[176:179], v[160:175]
    v_exp_f32 v41, v41
    v_mfma_f32_32x32x8_bf16 v[48:63], v[22:23], v[20:21], v[48:63]
    v_exp_f32 v42, v42
    v_cvt_pk_bf16_f32 v68, v40, v41
    s_setprio 3
    v_exp_f32 v43, v43
    v_exp_f32 v44, v44
    ds_read_b128 v[24:27], v213 offset:16384
    v_cvt_pk_bf16_f32 v69, v42, v43
    s_waitcnt lgkmcnt(5)
    v_mfma_f32_32x32x16_bf16 v[80:95], v[28:31], v[64:67], v[80:95]
    ds_read_b64 v[22:23], v214 offset:18944
    s_add_u32 m0, s15, 157696
    s_mov_b32 s16, 116736
    s_mov_b64 exec, s[10:11]
    buffer_load_dwordx4 v206, s[64:67], s16 offen sc1 lds
    s_mov_b64 exec, -1
    v_exp_f32 v45, v45
    v_exp_f32 v46, v46
    s_waitcnt lgkmcnt(3)
    v_mfma_f32_32x32x16_bf16 v[144:159], v[192:195], v[188:191], v[144:159]
    v_cvt_pk_bf16_f32 v70, v44, v45
    v_exp_f32 v47, v47
    v_exp_f32 v48, v48
    v_cvt_pk_bf16_f32 v71, v46, v47
    v_exp_f32 v49, v49
    v_exp_f32 v50, v50
    s_waitcnt lgkmcnt(2)
    v_mfma_f32_32x32x16_bf16 v[80:95], v[200:203], v[68:71], v[80:95]
    v_cvt_pk_bf16_f32 v72, v48, v49
    v_exp_f32 v51, v51
    v_exp_f32 v52, v52
    v_mfma_f32_32x32x16_bf16 v[160:175], v[196:199], v[188:191], v[160:175]
    v_cvt_pk_bf16_f32 v73, v50, v51
    v_exp_f32 v53, v53
    v_cvt_pk_bf16_f32 v128, v144, v145
    v_cvt_pk_bf16_f32 v129, v146, v147
    v_exp_f32 v54, v54
    v_cvt_pk_bf16_f32 v130, v148, v149
    v_cvt_pk_bf16_f32 v131, v150, v151
    s_waitcnt lgkmcnt(1)
    v_mfma_f32_32x32x16_bf16 v[32:47], v[24:27], v[8:11], 0
    s_setprio 2
    v_cvt_pk_bf16_f32 v132, v152, v153
    v_cvt_pk_bf16_f32 v133, v154, v155
    v_cvt_pk_bf16_f32 v74, v52, v53
    v_cvt_pk_bf16_f32 v134, v156, v157
    v_cvt_pk_bf16_f32 v135, v158, v159
    v_exp_f32 v55, v55
    v_mfma_f32_32x32x16_bf16 v[176:191], v[128:131], v[120:123], 0
    v_cvt_pk_bf16_f32 v192, v160, v161
    v_exp_f32 v56, v56
    v_cvt_pk_bf16_f32 v193, v162, v163
    v_cvt_pk_bf16_f32 v194, v164, v165
    v_cvt_pk_bf16_f32 v75, v54, v55
    v_mfma_f32_32x32x16_bf16 v[176:191], v[132:135], v[124:127], v[176:191]
    v_cvt_pk_bf16_f32 v195, v166, v167
    v_exp_f32 v57, v57
    v_cvt_pk_bf16_f32 v196, v168, v169
    v_cvt_pk_bf16_f32 v197, v170, v171
    s_waitcnt lgkmcnt(0)
    v_mfma_f32_32x32x8_bf16 v[32:47], v[22:23], v[12:13], v[32:47]
    v_mfma_f32_32x32x16_bf16 v[144:159], v[128:131], v[112:115], 0
    v_cvt_pk_bf16_f32 v198, v172, v173
    v_exp_f32 v58, v58
    v_cvt_pk_bf16_f32 v199, v174, v175
    v_cvt_pk_bf16_f32 v76, v56, v57
    v_mfma_f32_32x32x16_bf16 v[144:159], v[132:135], v[116:119], v[144:159]
    v_exp_f32 v59, v59
    v_exp_f32 v60, v60
    v_cvt_pk_bf16_f32 v77, v58, v59
    v_mfma_f32_32x32x16_bf16 v[160:175], v[192:195], v[112:115], 0
    v_mfma_f32_32x32x16_bf16 v[96:111], v[28:31], v[72:75], v[96:111]
    v_exp_f32 v61, v61
    ds_read_b128 v[28:31], v215 offset:17408
    v_mfma_f32_32x32x16_bf16 v[160:175], v[196:199], v[116:119], v[160:175]
    v_exp_f32 v62, v62
    s_nop 2
    v_sub_f32 v144, v144, v184
    v_sub_f32 v145, v145, v185
    v_cvt_pk_bf16_f32 v78, v60, v61
    v_sub_f32 v146, v146, v186
    v_sub_f32 v147, v147, v187
    v_exp_f32 v63, v63
    v_sub_f32 v148, v148, v188
    v_sub_f32 v149, v149, v189
    v_exp_f32 v32, v32
    v_sub_f32 v150, v150, v190
    v_sub_f32 v151, v151, v191
    v_cvt_pk_bf16_f32 v79, v62, v63
    v_add_f32 v152, v152, v176
    v_add_f32 v153, v153, v177
    v_exp_f32 v33, v33
    v_add_f32 v154, v154, v178
    v_add_f32 v155, v155, v179
    v_exp_f32 v34, v34
    s_setprio 1
    v_add_f32 v156, v156, v180
    v_add_f32 v157, v157, v181
    v_mfma_f32_32x32x16_bf16 v[96:111], v[200:203], v[76:79], v[96:111]
    v_add_f32 v158, v158, v182
    v_add_f32 v159, v159, v183
    v_cvt_pk_bf16_f32 v64, v32, v33
    ds_read_b128 v[200:203], v215 offset:18176
    v_mfma_f32_32x32x16_bf16 v[176:191], v[192:195], v[120:123], 0
    v_exp_f32 v35, v35
    v_exp_f32 v36, v36
    v_mfma_f32_32x32x16_bf16 v[176:191], v[196:199], v[124:127], v[176:191]
    v_cvt_pk_bf16_f32 v65, v34, v35
    v_exp_f32 v37, v37
    v_exp_f32 v38, v38
    v_mfma_f32_32x32x16_bf16 v[48:63], v[24:27], v[16:19], 0
    v_cvt_pk_bf16_f32 v66, v36, v37
    s_nop 6
    v_sub_f32 v160, v160, v184
    v_sub_f32 v161, v161, v185
    v_exp_f32 v39, v39
    v_cvt_pk_bf16_f32 v144, v144, v160
    v_sub_f32 v162, v162, v186
    v_exp_f32 v40, v40
    v_cvt_pk_bf16_f32 v145, v145, v161
    v_sub_f32 v163, v163, v187
    v_cvt_pk_bf16_f32 v67, v38, v39
    s_setprio 0
    v_cvt_pk_bf16_f32 v146, v146, v162
    v_sub_f32 v164, v164, v188
    v_exp_f32 v41, v41
    v_cvt_pk_bf16_f32 v147, v147, v163
    v_sub_f32 v165, v165, v189
    v_mfma_f32_32x32x8_bf16 v[48:63], v[22:23], v[20:21], v[48:63]
    v_cvt_pk_bf16_f32 v148, v148, v164
    v_sub_f32 v166, v166, v190
    v_exp_f32 v42, v42
    v_cvt_pk_bf16_f32 v149, v149, v165
    v_sub_f32 v167, v167, v191
    v_cvt_pk_bf16_f32 v68, v40, v41
    v_cvt_pk_bf16_f32 v150, v150, v166
    v_add_f32 v168, v168, v176
    s_waitcnt vmcnt(1) lgkmcnt(0)
    s_barrier
    v_cvt_pk_bf16_f32 v151, v151, v167
    v_add_f32 v169, v169, v177
    v_exp_f32 v43, v43
    v_cvt_pk_bf16_f32 v152, v152, v168
    v_add_f32 v170, v170, v178
    v_exp_f32 v44, v44
    ds_read_b128 v[24:27], v213 offset:22528
    v_cvt_pk_bf16_f32 v153, v153, v169
    v_add_f32 v171, v171, v179
    v_cvt_pk_bf16_f32 v69, v42, v43
    v_cvt_pk_bf16_f32 v154, v154, v170
    v_add_f32 v172, v172, v180
    v_mfma_f32_32x32x16_bf16 v[80:95], v[28:31], v[64:67], v[80:95]
    ds_read_b64 v[22:23], v214 offset:25088
    v_cvt_pk_bf16_f32 v155, v155, v171
    v_add_f32 v173, v173, v181
    s_add_u32 m0, s15, 133120
    s_mov_b32 s16, 122880
    s_mov_b64 exec, s[10:11]
    buffer_load_dwordx4 v206, s[64:67], s16 offen sc1 lds
    s_mov_b64 exec, -1
    v_exp_f32 v45, v45
    v_cvt_pk_bf16_f32 v156, v156, v172
    v_add_f32 v174, v174, v182
    v_exp_f32 v46, v46
    v_cvt_pk_bf16_f32 v157, v157, v173
    v_add_f32 v175, v175, v183
    v_cvt_pk_bf16_f32 v70, v44, v45
    v_cvt_pk_bf16_f32 v158, v158, v174
    v_cvt_pk_bf16_f32 v159, v159, v175
    v_exp_f32 v47, v47
    v_permlane16_swap_b32 v144, v148
    v_permlane16_swap_b32 v145, v149
    v_exp_f32 v48, v48
    v_permlane16_swap_b32 v146, v150
    v_permlane16_swap_b32 v147, v151
    v_cvt_pk_bf16_f32 v71, v46, v47
    s_add_u32 s99, s98, 0
    buffer_store_dwordx4 v[144:147], v253, s[64:67], s99 offen sc1
    s_add_u32 s99, s98, 1572864
    buffer_store_dwordx4 v[148:151], v253, s[64:67], s99 offen sc1
    v_exp_f32 v49, v49
    v_permlane16_swap_b32 v152, v156
    v_permlane16_swap_b32 v153, v157
    v_exp_f32 v50, v50
    v_permlane16_swap_b32 v154, v158
    v_permlane16_swap_b32 v155, v159
    v_mfma_f32_32x32x16_bf16 v[80:95], v[200:203], v[68:71], v[80:95]
    s_add_u32 s99, s98, 49152
    buffer_store_dwordx4 v[152:155], v253, s[64:67], s99 offen sc1
    s_add_u32 s99, s98, 1622016
    buffer_store_dwordx4 v[156:159], v253, s[64:67], s99 offen sc1
    v_cvt_pk_bf16_f32 v72, v48, v49
    v_exp_f32 v51, v51
    v_exp_f32 v52, v52
    v_cvt_pk_bf16_f32 v73, v50, v51
    v_exp_f32 v53, v53
    v_exp_f32 v54, v54
    s_waitcnt lgkmcnt(1)
    v_mfma_f32_32x32x16_bf16 v[32:47], v[24:27], v[8:11], 0
    v_cvt_pk_bf16_f32 v74, v52, v53
    v_exp_f32 v55, v55
    v_exp_f32 v56, v56
    v_cvt_pk_bf16_f32 v75, v54, v55
    v_exp_f32 v57, v57
    s_waitcnt lgkmcnt(0)
    v_mfma_f32_32x32x8_bf16 v[32:47], v[22:23], v[12:13], v[32:47]
    v_exp_f32 v58, v58
    v_cvt_pk_bf16_f32 v76, v56, v57
    v_exp_f32 v59, v59
    v_exp_f32 v60, v60
    v_cvt_pk_bf16_f32 v77, v58, v59
    v_mfma_f32_32x32x16_bf16 v[96:111], v[28:31], v[72:75], v[96:111]
    v_exp_f32 v61, v61
    ds_read_b128 v[28:31], v215 offset:23552
    v_exp_f32 v62, v62
    v_cvt_pk_bf16_f32 v78, v60, v61
    v_exp_f32 v63, v63
    s_nop 0
    v_exp_f32 v32, v32
    v_cvt_pk_bf16_f32 v79, v62, v63
    v_exp_f32 v33, v33
    v_exp_f32 v34, v34
    v_mfma_f32_32x32x16_bf16 v[96:111], v[200:203], v[76:79], v[96:111]
    v_cvt_pk_bf16_f32 v64, v32, v33
    ds_read_b128 v[200:203], v215 offset:24320
    v_exp_f32 v35, v35
    v_exp_f32 v36, v36
    v_cvt_pk_bf16_f32 v65, v34, v35
    v_exp_f32 v37, v37
    v_exp_f32 v38, v38
    v_mfma_f32_32x32x16_bf16 v[48:63], v[24:27], v[16:19], 0
    v_cvt_pk_bf16_f32 v66, v36, v37
    v_exp_f32 v39, v39
    v_exp_f32 v40, v40
    v_cvt_pk_bf16_f32 v67, v38, v39
    v_exp_f32 v41, v41
    v_mfma_f32_32x32x8_bf16 v[48:63], v[22:23], v[20:21], v[48:63]
    v_exp_f32 v42, v42
    v_cvt_pk_bf16_f32 v68, v40, v41
    v_exp_f32 v43, v43
    v_exp_f32 v44, v44
    ds_read_b128 v[24:27], v213 offset:28672
    v_cvt_pk_bf16_f32 v69, v42, v43
    s_waitcnt lgkmcnt(2)
    v_mfma_f32_32x32x16_bf16 v[80:95], v[28:31], v[64:67], v[80:95]
    ds_read_b64 v[22:23], v214 offset:31232
    s_add_u32 m0, s15, 139264
    s_mov_b32 s16, 129024
    s_mov_b64 exec, s[10:11]
    buffer_load_dwordx4 v206, s[64:67], s16 offen sc1 lds
    s_mov_b64 exec, -1
    v_exp_f32 v45, v45
    v_exp_f32 v46, v46
    v_cvt_pk_bf16_f32 v70, v44, v45
    v_exp_f32 v47, v47
    v_exp_f32 v48, v48
    v_cvt_pk_bf16_f32 v71, v46, v47
    v_exp_f32 v49, v49
    v_exp_f32 v50, v50
    s_waitcnt lgkmcnt(2)
    v_mfma_f32_32x32x16_bf16 v[80:95], v[200:203], v[68:71], v[80:95]
    v_cvt_pk_bf16_f32 v72, v48, v49
    v_exp_f32 v51, v51
    v_exp_f32 v52, v52
    v_cvt_pk_bf16_f32 v73, v50, v51
    v_exp_f32 v53, v53
    v_exp_f32 v54, v54
    s_waitcnt lgkmcnt(1)
    v_mfma_f32_32x32x16_bf16 v[32:47], v[24:27], v[8:11], 0
    v_cvt_pk_bf16_f32 v74, v52, v53
    v_exp_f32 v55, v55
    v_exp_f32 v56, v56
    v_cvt_pk_bf16_f32 v75, v54, v55
    v_exp_f32 v57, v57
    s_waitcnt lgkmcnt(0)
    v_mfma_f32_32x32x8_bf16 v[32:47], v[22:23], v[12:13], v[32:47]
    v_exp_f32 v58, v58
    v_cvt_pk_bf16_f32 v76, v56, v57
    v_exp_f32 v59, v59
    v_exp_f32 v60, v60
    v_cvt_pk_bf16_f32 v77, v58, v59
    v_mfma_f32_32x32x16_bf16 v[96:111], v[28:31], v[72:75], v[96:111]
    v_exp_f32 v61, v61
    ds_read_b128 v[28:31], v215 offset:29696
    v_exp_f32 v62, v62
    v_cvt_pk_bf16_f32 v78, v60, v61
    v_exp_f32 v63, v63
    s_nop 0
    v_exp_f32 v32, v32
    v_cvt_pk_bf16_f32 v79, v62, v63
    v_exp_f32 v33, v33
    v_exp_f32 v34, v34
    v_mfma_f32_32x32x16_bf16 v[96:111], v[200:203], v[76:79], v[96:111]
    v_cvt_pk_bf16_f32 v64, v32, v33
    ds_read_b128 v[200:203], v215 offset:30464
    v_exp_f32 v35, v35
    v_exp_f32 v36, v36
    v_cvt_pk_bf16_f32 v65, v34, v35
    v_exp_f32 v37, v37
    v_exp_f32 v38, v38
    v_mfma_f32_32x32x16_bf16 v[48:63], v[24:27], v[16:19], 0
    v_cvt_pk_bf16_f32 v66, v36, v37
    v_exp_f32 v39, v39
    v_exp_f32 v40, v40
    v_cvt_pk_bf16_f32 v67, v38, v39
    v_exp_f32 v41, v41
    v_mfma_f32_32x32x8_bf16 v[48:63], v[22:23], v[20:21], v[48:63]
    v_exp_f32 v42, v42
    v_cvt_pk_bf16_f32 v68, v40, v41
    s_waitcnt vmcnt(5) lgkmcnt(0)
    s_barrier
    v_exp_f32 v43, v43
    v_exp_f32 v44, v44
    ds_read_b128 v[24:27], v213 offset:34816
    v_cvt_pk_bf16_f32 v69, v42, v43
    v_mfma_f32_32x32x16_bf16 v[80:95], v[28:31], v[64:67], v[80:95]
    ds_read_b64 v[22:23], v214 offset:37376
    s_add_u32 m0, s15, 145408
    s_mov_b32 s16, 135168
    s_mov_b64 exec, s[10:11]
    buffer_load_dwordx4 v206, s[64:67], s16 offen sc1 lds
    s_mov_b64 exec, -1
    v_exp_f32 v45, v45
    v_exp_f32 v46, v46
    v_cvt_pk_bf16_f32 v70, v44, v45
    v_exp_f32 v47, v47
    v_exp_f32 v48, v48
    v_cvt_pk_bf16_f32 v71, v46, v47
    v_exp_f32 v49, v49
    v_exp_f32 v50, v50
    v_mfma_f32_32x32x16_bf16 v[80:95], v[200:203], v[68:71], v[80:95]
    v_cvt_pk_bf16_f32 v72, v48, v49
    v_exp_f32 v51, v51
    v_exp_f32 v52, v52
    v_cvt_pk_bf16_f32 v73, v50, v51
    v_exp_f32 v53, v53
    v_exp_f32 v54, v54
    s_waitcnt lgkmcnt(1)
    v_mfma_f32_32x32x16_bf16 v[32:47], v[24:27], v[8:11], 0
    v_cvt_pk_bf16_f32 v74, v52, v53
    v_exp_f32 v55, v55
    v_exp_f32 v56, v56
    v_cvt_pk_bf16_f32 v75, v54, v55
    v_exp_f32 v57, v57
    s_waitcnt lgkmcnt(0)
    v_mfma_f32_32x32x8_bf16 v[32:47], v[22:23], v[12:13], v[32:47]
    v_exp_f32 v58, v58
    v_cvt_pk_bf16_f32 v76, v56, v57
    v_exp_f32 v59, v59
    v_exp_f32 v60, v60
    v_cvt_pk_bf16_f32 v77, v58, v59
    v_mfma_f32_32x32x16_bf16 v[96:111], v[28:31], v[72:75], v[96:111]
    v_exp_f32 v61, v61
    ds_read_b128 v[28:31], v215 offset:35840
    v_exp_f32 v62, v62
    v_cvt_pk_bf16_f32 v78, v60, v61
    v_exp_f32 v63, v63
    s_nop 0
    v_exp_f32 v32, v32
    v_cvt_pk_bf16_f32 v79, v62, v63
    v_exp_f32 v33, v33
    v_exp_f32 v34, v34
    v_mfma_f32_32x32x16_bf16 v[96:111], v[200:203], v[76:79], v[96:111]
    v_cvt_pk_bf16_f32 v64, v32, v33
    ds_read_b128 v[200:203], v215 offset:36608
    v_exp_f32 v35, v35
    v_exp_f32 v36, v36
    v_cvt_pk_bf16_f32 v65, v34, v35
    v_exp_f32 v37, v37
    v_exp_f32 v38, v38
    v_mfma_f32_32x32x16_bf16 v[48:63], v[24:27], v[16:19], 0
    v_cvt_pk_bf16_f32 v66, v36, v37
    v_exp_f32 v39, v39
    v_exp_f32 v40, v40
    v_cvt_pk_bf16_f32 v67, v38, v39
    v_exp_f32 v41, v41
    v_mfma_f32_32x32x8_bf16 v[48:63], v[22:23], v[20:21], v[48:63]
    v_exp_f32 v42, v42
    v_cvt_pk_bf16_f32 v68, v40, v41
    v_exp_f32 v43, v43
    v_exp_f32 v44, v44
    ds_read_b128 v[24:27], v213 offset:10240
    v_cvt_pk_bf16_f32 v69, v42, v43
    s_waitcnt lgkmcnt(2)
    v_mfma_f32_32x32x16_bf16 v[80:95], v[28:31], v[64:67], v[80:95]
    ds_read_b64 v[22:23], v214 offset:12800
    s_add_u32 m0, s15, 151552
    s_mov_b32 s16, 141312
    s_mov_b64 exec, s[10:11]
    buffer_load_dwordx4 v206, s[64:67], s16 offen sc1 lds
    s_mov_b64 exec, -1
    v_exp_f32 v45, v45
    v_exp_f32 v46, v46
    v_cvt_pk_bf16_f32 v70, v44, v45
    v_exp_f32 v47, v47
    v_exp_f32 v48, v48
    v_cvt_pk_bf16_f32 v71, v46, v47
    v_exp_f32 v49, v49
    v_exp_f32 v50, v50
    s_waitcnt lgkmcnt(2)
    v_mfma_f32_32x32x16_bf16 v[80:95], v[200:203], v[68:71], v[80:95]
    v_cvt_pk_bf16_f32 v72, v48, v49
    v_exp_f32 v51, v51
    v_exp_f32 v52, v52
    v_cvt_pk_bf16_f32 v73, v50, v51
    v_exp_f32 v53, v53
    v_exp_f32 v54, v54
    s_waitcnt lgkmcnt(1)
    v_mfma_f32_32x32x16_bf16 v[32:47], v[24:27], v[8:11], 0
    v_cvt_pk_bf16_f32 v74, v52, v53
    v_exp_f32 v55, v55
    v_exp_f32 v56, v56
    v_cvt_pk_bf16_f32 v75, v54, v55
    v_exp_f32 v57, v57
    s_waitcnt lgkmcnt(0)
    v_mfma_f32_32x32x8_bf16 v[32:47], v[22:23], v[12:13], v[32:47]
    v_exp_f32 v58, v58
    v_cvt_pk_bf16_f32 v76, v56, v57
    v_exp_f32 v59, v59
    v_exp_f32 v60, v60
    v_cvt_pk_bf16_f32 v77, v58, v59
    v_mfma_f32_32x32x16_bf16 v[96:111], v[28:31], v[72:75], v[96:111]
    v_exp_f32 v61, v61
    ds_read_b128 v[28:31], v215 offset:11264
    v_exp_f32 v62, v62
    v_cvt_pk_bf16_f32 v78, v60, v61
    v_exp_f32 v63, v63
    s_nop 0
    v_exp_f32 v32, v32
    v_cvt_pk_bf16_f32 v79, v62, v63
    v_exp_f32 v33, v33
    v_exp_f32 v34, v34
    v_mfma_f32_32x32x16_bf16 v[96:111], v[200:203], v[76:79], v[96:111]
    v_cvt_pk_bf16_f32 v64, v32, v33
    ds_read_b128 v[200:203], v215 offset:12032
    v_exp_f32 v35, v35
    v_exp_f32 v36, v36
    v_cvt_pk_bf16_f32 v65, v34, v35
    v_exp_f32 v37, v37
    v_exp_f32 v38, v38
    v_mfma_f32_32x32x16_bf16 v[48:63], v[24:27], v[16:19], 0
    v_cvt_pk_bf16_f32 v66, v36, v37
    v_exp_f32 v39, v39
    v_exp_f32 v40, v40
    v_cvt_pk_bf16_f32 v67, v38, v39
    v_exp_f32 v41, v41
    v_mfma_f32_32x32x8_bf16 v[48:63], v[22:23], v[20:21], v[48:63]
    v_exp_f32 v42, v42
    v_cvt_pk_bf16_f32 v68, v40, v41
    s_waitcnt vmcnt(3)
    s_waitcnt vmcnt(1) lgkmcnt(0)
    s_barrier
    s_cmp_lg_u32 s92, 7
    s_cbranch_scc1 sza1
    s_and_b32 s3, s2, 15
    s_lshl_b32 s3, s3, 8
    s_add_u32 s3, s3, 299008
    v_mov_b32 v232, s3
    v_mov_b32 v233, 1
    s_mov_b64 exec, 1
    buffer_atomic_add v233, v232, s[64:67], 0 offen sc1
    s_mov_b64 exec, -1
sza1:
    s_setprio 3
    v_exp_f32 v43, v43
    v_exp_f32 v44, v44
    ds_read_b128 v[24:27], v213 offset:16384
    v_cvt_pk_bf16_f32 v69, v42, v43
    v_mfma_f32_32x32x16_bf16 v[80:95], v[28:31], v[64:67], v[80:95]
    ds_read_b64 v[22:23], v214 offset:18944
    s_add_u32 m0, s15, 157696
    s_mov_b32 s16, 147456
    s_mov_b64 exec, s[10:11]
    buffer_load_dwordx4 v206, s[64:67], s16 offen sc1 lds
    s_mov_b64 exec, -1
    v_exp_f32 v45, v45
    v_exp_f32 v46, v46
    v_cvt_pk_bf16_f32 v70, v44, v45
    v_exp_f32 v47, v47
    v_exp_f32 v48, v48
    v_cvt_pk_bf16_f32 v71, v46, v47
    v_exp_f32 v49, v49
    s_add_u32 m0, s21, 0
    s_mov_b64 exec, s[12:13]
    buffer_load_dwordx4 v209, s[72:75], 0 offen lds
    s_mov_b64 exec, -1
    v_exp_f32 v50, v50
    v_mfma_f32_32x32x16_bf16 v[80:95], v[200:203], v[68:71], v[80:95]
    v_cvt_pk_bf16_f32 v72, v48, v49
    v_exp_f32 v51, v51
    v_exp_f32 v52, v52
    v_cvt_pk_bf16_f32 v73, v50, v51
    v_exp_f32 v53, v53
    s_add_u32 m0, s21, 6400
    s_mov_b32 s16, 51200
    s_mov_b64 exec, s[12:13]
    buffer_load_dwordx4 v209, s[72:75], s16 offen lds
    s_mov_b64 exec, -1
    v_exp_f32 v54, v54
    s_waitcnt lgkmcnt(1)
    v_mfma_f32_32x32x16_bf16 v[32:47], v[24:27], v[8:11], 0
    s_setprio 2
    v_cvt_pk_bf16_f32 v74, v52, v53
    v_exp_f32 v55, v55
    v_exp_f32 v56, v56
    v_cvt_pk_bf16_f32 v75, v54, v55
    v_exp_f32 v57, v57
    s_add_u32 m0, s21, 12800
    s_mov_b32 s16, 102400
    s_mov_b64 exec, s[12:13]
    buffer_load_dwordx4 v209, s[72:75], s16 offen lds
    s_mov_b64 exec, -1
    s_waitcnt lgkmcnt(0)
    v_mfma_f32_32x32x8_bf16 v[32:47], v[22:23], v[12:13], v[32:47]
    v_exp_f32 v58, v58
    v_cvt_pk_bf16_f32 v76, v56, v57
    v_exp_f32 v59, v59
    v_exp_f32 v60, v60
    v_cvt_pk_bf16_f32 v77, v58, v59
    v_mfma_f32_32x32x16_bf16 v[96:111], v[28:31], v[72:75], v[96:111]
    v_exp_f32 v61, v61
    ds_read_b128 v[28:31], v215 offset:17408
    v_exp_f32 v62, v62
    v_cvt_pk_bf16_f32 v78, v60, v61
    v_exp_f32 v63, v63
    s_waitcnt lgkmcnt(0)
    s_nop 5
    s_branch l_j
l_n:
    s_nop 7
    v_exp_f32 v32, v32
    v_exp_f32 v33, v33
    v_exp_f32 v34, v34
    v_cvt_pk_bf16_f32 v64, v32, v33
    ds_read_b128 v[200:203], v7 offset:12032
    v_exp_f32 v35, v35
    v_exp_f32 v36, v36
    v_cvt_pk_bf16_f32 v65, v34, v35
    v_exp_f32 v37, v37
    v_exp_f32 v38, v38
    s_waitcnt lgkmcnt(2)
    v_mfma_f32_32x32x16_bf16 v[48:63], v[24:27], v[16:19], 0
    v_cvt_pk_bf16_f32 v66, v36, v37
    v_exp_f32 v39, v39
    v_exp_f32 v40, v40
    v_cvt_pk_bf16_f32 v67, v38, v39
    v_exp_f32 v41, v41
    s_waitcnt lgkmcnt(1)
    v_mfma_f32_32x32x8_bf16 v[48:63], v[22:23], v[20:21], v[48:63]
    v_exp_f32 v42, v42
    v_cvt_pk_bf16_f32 v68, v40, v41
    s_waitcnt vmcnt(2)
    s_barrier
    s_setprio 3
    v_exp_f32 v43, v43
    ds_read_b128 v[8:11], v190
    v_exp_f32 v44, v44
    ds_read_b128 v[24:27], v213 offset:16384
    v_cvt_pk_bf16_f32 v69, v42, v43
    v_mfma_f32_32x32x16_bf16 v[96:111], v[28:31], v[64:67], 0
    ds_read_b64 v[22:23], v214 offset:18944
    s_add_u32 m0, s15, 157696
    s_mov_b32 s16, 24576
    s_mov_b64 exec, s[10:11]
    buffer_load_dwordx4 v206, s[64:67], s16 offen sc1 lds
    s_mov_b64 exec, -1
    v_exp_f32 v45, v45
    ds_read_b128 v[28:31], v7 offset:14336
    ds_read_b64 v[12:13], v191 offset:1024
    v_exp_f32 v46, v46
    v_cvt_pk_bf16_f32 v70, v44, v45
    v_exp_f32 v47, v47
    v_exp_f32 v48, v48
    v_cvt_pk_bf16_f32 v71, v46, v47
    v_exp_f32 v49, v49
    v_exp_f32 v50, v50
    s_waitcnt lgkmcnt(5)
    v_mfma_f32_32x32x16_bf16 v[96:111], v[200:203], v[68:71], v[96:111]
    v_cvt_pk_bf16_f32 v72, v48, v49
    ds_read_b128 v[200:203], v7 offset:15104
    s_lshl_b32 s23, s23, 7
    s_add_u32 m0, s15, 81920
    s_mov_b64 exec, s[10:11]
    buffer_load_dwordx4 v208, s[56:59], s23 offen lds
    s_mov_b64 exec, -1
    v_exp_f32 v51, v51
    v_exp_f32 v52, v52
    v_cvt_pk_bf16_f32 v73, v50, v51
    v_exp_f32 v53, v53
    v_exp_f32 v54, v54
    s_waitcnt lgkmcnt(4)
    v_mfma_f32_32x32x16_bf16 v[32:47], v[24:27], v[8:11], 0
    s_setprio 2
    v_cvt_pk_bf16_f32 v74, v52, v53
    v_exp_f32 v55, v55
    v_exp_f32 v56, v56
    v_cvt_pk_bf16_f32 v75, v54, v55
    s_add_u32 m0, s15, 88064
    s_mov_b64 exec, s[10:11]
    buffer_load_dwordx4 v208, s[60:63], s23 offen lds
    s_mov_b64 exec, -1
    s_add_u32 s23, s23, 128
    s_cmp_eq_u32 s23, 1280
    s_cselect_b32 s23, 0, s23
    v_exp_f32 v57, v57
    s_waitcnt lgkmcnt(1)
    v_mfma_f32_32x32x8_bf16 v[32:47], v[22:23], v[12:13], v[32:47]
    v_exp_f32 v58, v58
    v_cvt_pk_bf16_f32 v76, v56, v57
    v_exp_f32 v59, v59
    v_exp_f32 v60, v60
    v_cvt_pk_bf16_f32 v77, v58, v59
    v_mfma_f32_32x32x16_bf16 v[96:111], v[28:31], v[72:75], v[96:111]
    v_exp_f32 v61, v61
    ds_read_b128 v[28:31], v215 offset:17408
    v_exp_f32 v62, v62
    v_cvt_pk_bf16_f32 v78, v60, v61
    v_exp_f32 v63, v63
    s_nop 0
    v_exp_f32 v32, v32
    v_cvt_pk_bf16_f32 v79, v62, v63
    v_exp_f32 v33, v33
    v_exp_f32 v34, v34
    s_setprio 1
    s_waitcnt lgkmcnt(1)
    v_mfma_f32_32x32x16_bf16 v[96:111], v[200:203], v[76:79], v[96:111]
    v_cvt_pk_bf16_f32 v64, v32, v33
    ds_read_b128 v[200:203], v215 offset:18176
    v_exp_f32 v35, v35
    v_exp_f32 v36, v36
    v_cvt_pk_bf16_f32 v65, v34, v35
    v_exp_f32 v37, v37
    v_exp_f32 v38, v38
    v_mfma_f32_32x32x16_bf16 v[48:63], v[24:27], v[16:19], 0
    v_cvt_pk_bf16_f32 v66, v36, v37
    v_exp_f32 v39, v39
    v_exp_f32 v40, v40
    v_cvt_pk_bf16_f32 v67, v38, v39
    s_setprio 0
    v_exp_f32 v41, v41
    v_mfma_f32_32x32x8_bf16 v[48:63], v[22:23], v[20:21], v[48:63]
    v_exp_f32 v42, v42
    v_cvt_pk_bf16_f32 v68, v40, v41
    s_waitcnt vmcnt(4)
    s_barrier
    s_setprio 3
    v_exp_f32 v43, v43
    v_exp_f32 v44, v44
    ds_read_b128 v[24:27], v213 offset:22528
    v_cvt_pk_bf16_f32 v69, v42, v43
    s_waitcnt lgkmcnt(2)
    v_mfma_f32_32x32x16_bf16 v[80:95], v[28:31], v[64:67], 0
    ds_read_b64 v[22:23], v214 offset:25088
    s_add_u32 m0, s15, 133120
    s_mov_b32 s16, 30720
    s_mov_b64 exec, s[10:11]
    buffer_load_dwordx4 v206, s[64:67], s16 offen sc1 lds
    s_mov_b64 exec, -1
    v_exp_f32 v45, v45
    v_exp_f32 v46, v46
    v_cvt_pk_bf16_f32 v70, v44, v45
    v_exp_f32 v47, v47
    v_exp_f32 v48, v48
    v_cvt_pk_bf16_f32 v71, v46, v47
    v_exp_f32 v49, v49
    v_exp_f32 v50, v50
    s_waitcnt lgkmcnt(2)
    v_mfma_f32_32x32x16_bf16 v[80:95], v[200:203], v[68:71], v[80:95]
    v_cvt_pk_bf16_f32 v72, v48, v49
    s_add_u32 m0, s15, 94208
    s_mov_b64 exec, s[10:11]
    buffer_load_dwordx4 v208, s[56:59], s23 offen lds
    s_mov_b64 exec, -1
    v_exp_f32 v51, v51
    v_exp_f32 v52, v52
    v_cvt_pk_bf16_f32 v73, v50, v51
    v_exp_f32 v53, v53
    v_exp_f32 v54, v54
    s_waitcnt lgkmcnt(1)
    v_mfma_f32_32x32x16_bf16 v[32:47], v[24:27], v[8:11], 0
    s_setprio 2
    v_cvt_pk_bf16_f32 v74, v52, v53
    v_exp_f32 v55, v55
    v_exp_f32 v56, v56
    v_cvt_pk_bf16_f32 v75, v54, v55
    s_add_u32 m0, s15, 100352
    s_mov_b64 exec, s[10:11]
    buffer_load_dwordx4 v208, s[60:63], s23 offen lds
    s_mov_b64 exec, -1
    s_add_u32 s23, s23, 128
    s_cmp_eq_u32 s23, 1280
    s_cselect_b32 s23, 0, s23
    v_exp_f32 v57, v57
    s_waitcnt lgkmcnt(0)
    v_mfma_f32_32x32x8_bf16 v[32:47], v[22:23], v[12:13], v[32:47]
    v_exp_f32 v58, v58
    v_cvt_pk_bf16_f32 v76, v56, v57
    v_exp_f32 v59, v59
    v_exp_f32 v60, v60
    v_cvt_pk_bf16_f32 v77, v58, v59
    v_mfma_f32_32x32x16_bf16 v[96:111], v[28:31], v[72:75], v[96:111]
    v_exp_f32 v61, v61
    ds_read_b128 v[28:31], v215 offset:23552
    v_exp_f32 v62, v62
    v_cvt_pk_bf16_f32 v78, v60, v61
    v_exp_f32 v63, v63
    s_nop 0
    v_exp_f32 v32, v32
    v_cvt_pk_bf16_f32 v79, v62, v63
    v_exp_f32 v33, v33
    v_exp_f32 v34, v34
    s_setprio 1
    v_mfma_f32_32x32x16_bf16 v[96:111], v[200:203], v[76:79], v[96:111]
    v_cvt_pk_bf16_f32 v64, v32, v33
    ds_read_b128 v[200:203], v215 offset:24320
    v_exp_f32 v35, v35
    v_exp_f32 v36, v36
    v_cvt_pk_bf16_f32 v65, v34, v35
    v_exp_f32 v37, v37
    v_exp_f32 v38, v38
    v_mfma_f32_32x32x16_bf16 v[48:63], v[24:27], v[16:19], 0
    v_cvt_pk_bf16_f32 v66, v36, v37
    v_exp_f32 v39, v39
    v_exp_f32 v40, v40
    v_cvt_pk_bf16_f32 v67, v38, v39
    s_setprio 0
    v_exp_f32 v41, v41
    v_mfma_f32_32x32x8_bf16 v[48:63], v[22:23], v[20:21], v[48:63]
    v_exp_f32 v42, v42
    v_cvt_pk_bf16_f32 v68, v40, v41
    s_waitcnt vmcnt(3)
    s_barrier
    s_setprio 3
    v_exp_f32 v43, v43
    v_exp_f32 v44, v44
    ds_read_b128 v[24:27], v213 offset:28672
    v_cvt_pk_bf16_f32 v69, v42, v43
    s_waitcnt lgkmcnt(2)
    v_mfma_f32_32x32x16_bf16 v[80:95], v[28:31], v[64:67], v[80:95]
    ds_read_b64 v[22:23], v214 offset:31232
    s_add_u32 m0, s15, 139264
    s_mov_b32 s16, 36864
    s_mov_b64 exec, s[10:11]
    buffer_load_dwordx4 v206, s[64:67], s16 offen sc1 lds
    s_mov_b64 exec, -1
    v_exp_f32 v45, v45
    v_exp_f32 v46, v46
    v_cvt_pk_bf16_f32 v70, v44, v45
    v_exp_f32 v47, v47
    v_exp_f32 v48, v48
    v_cvt_pk_bf16_f32 v71, v46, v47
    s_add_u32 m0, s15, 106496
    s_mov_b64 exec, s[10:11]
    buffer_load_dwordx4 v208, s[56:59], s23 offen lds
    s_mov_b64 exec, -1
    v_exp_f32 v49, v49
    v_exp_f32 v50, v50
    s_waitcnt lgkmcnt(2)
    v_mfma_f32_32x32x16_bf16 v[80:95], v[200:203], v[68:71], v[80:95]
    v_cvt_pk_bf16_f32 v72, v48, v49
    v_exp_f32 v51, v51
    v_exp_f32 v52, v52
    s_add_u32 m0, s15, 112640
    s_mov_b64 exec, s[10:11]
    buffer_load_dwordx4 v208, s[60:63], s23 offen lds
    s_mov_b64 exec, -1
    s_add_u32 s23, s23, 128
    s_cmp_eq_u32 s23, 1280
    s_cselect_b32 s23, 0, s23
    v_cvt_pk_bf16_f32 v73, v50, v51
    v_exp_f32 v53, v53
    v_exp_f32 v54, v54
    s_waitcnt lgkmcnt(1)
    v_mfma_f32_32x32x16_bf16 v[32:47], v[24:27], v[8:11], 0
    s_setprio 2
    v_cvt_pk_bf16_f32 v74, v52, v53
    v_exp_f32 v55, v55
    s_add_u32 m0, s15, 118784
    s_mov_b64 exec, s[10:11]
    buffer_load_dwordx4 v208, s[56:59], s23 offen lds
    s_mov_b64 exec, -1
    v_exp_f32 v56, v56
    v_cvt_pk_bf16_f32 v75, v54, v55
    v_exp_f32 v57, v57
    s_waitcnt lgkmcnt(0)
    v_mfma_f32_32x32x8_bf16 v[32:47], v[22:23], v[12:13], v[32:47]
    v_exp_f32 v58, v58
    v_cvt_pk_bf16_f32 v76, v56, v57
    s_add_u32 m0, s15, 124928
    s_mov_b64 exec, s[10:11]
    buffer_load_dwordx4 v208, s[60:63], s23 offen lds
    s_mov_b64 exec, -1
    s_add_u32 s23, s23, 128
    s_cmp_eq_u32 s23, 1280
    s_cselect_b32 s23, 0, s23
    v_exp_f32 v59, v59
    v_exp_f32 v60, v60
    v_cvt_pk_bf16_f32 v77, v58, v59
    v_mfma_f32_32x32x16_bf16 v[96:111], v[28:31], v[72:75], v[96:111]
    v_exp_f32 v61, v61
    ds_read_b128 v[28:31], v215 offset:29696
    v_exp_f32 v62, v62
    v_cvt_pk_bf16_f32 v78, v60, v61
    v_exp_f32 v63, v63
    v_exp_f32 v32, v32
    v_cvt_pk_bf16_f32 v79, v62, v63
    v_exp_f32 v33, v33
    v_exp_f32 v34, v34
    s_setprio 1
    v_mfma_f32_32x32x16_bf16 v[96:111], v[200:203], v[76:79], v[96:111]
    v_cvt_pk_bf16_f32 v64, v32, v33
    ds_read_b128 v[200:203], v215 offset:30464
    v_exp_f32 v35, v35
    v_exp_f32 v36, v36
    v_cvt_pk_bf16_f32 v65, v34, v35
    v_exp_f32 v37, v37
    v_exp_f32 v38, v38
    v_mfma_f32_32x32x16_bf16 v[48:63], v[24:27], v[16:19], 0
    v_cvt_pk_bf16_f32 v66, v36, v37
    v_exp_f32 v39, v39
    v_exp_f32 v40, v40
    v_cvt_pk_bf16_f32 v67, v38, v39
    s_setprio 0
    v_exp_f32 v41, v41
    v_mfma_f32_32x32x8_bf16 v[48:63], v[22:23], v[20:21], v[48:63]
    v_exp_f32 v42, v42
    v_cvt_pk_bf16_f32 v68, v40, v41
    s_waitcnt vmcnt(5)
    s_barrier
    s_setprio 3
    v_exp_f32 v43, v43
    v_exp_f32 v44, v44
    ds_read_b128 v[24:27], v213 offset:34816
    v_cvt_pk_bf16_f32 v69, v42, v43
    s_waitcnt lgkmcnt(2)
    v_mfma_f32_32x32x16_bf16 v[80:95], v[28:31], v[64:67], v[80:95]
    ds_read_b64 v[22:23], v214 offset:37376
    s_add_u32 m0, s15, 145408
    s_mov_b32 s16, 43008
    s_mov_b64 exec, s[10:11]
    buffer_load_dwordx4 v206, s[64:67], s16 offen sc1 lds
    s_mov_b64 exec, -1
    v_exp_f32 v45, v45
    v_exp_f32 v46, v46
    v_cvt_pk_bf16_f32 v70, v44, v45
    v_exp_f32 v47, v47
    v_exp_f32 v48, v48
    v_cvt_pk_bf16_f32 v71, v46, v47
    v_exp_f32 v49, v49
    v_exp_f32 v50, v50
    s_waitcnt lgkmcnt(2)
    v_mfma_f32_32x32x16_bf16 v[80:95], v[200:203], v[68:71], v[80:95]
    v_cvt_pk_bf16_f32 v72, v48, v49
    v_exp_f32 v51, v51
    v_exp_f32 v52, v52
    v_cvt_pk_bf16_f32 v73, v50, v51
    v_exp_f32 v53, v53
    v_exp_f32 v54, v54
    s_waitcnt lgkmcnt(1)
    v_mfma_f32_32x32x16_bf16 v[32:47], v[24:27], v[8:11], 0
    s_setprio 2
    v_cvt_pk_bf16_f32 v74, v52, v53
    v_exp_f32 v55, v55
    v_exp_f32 v56, v56
    v_cvt_pk_bf16_f32 v75, v54, v55
    v_exp_f32 v57, v57
    s_waitcnt lgkmcnt(0)
    v_mfma_f32_32x32x8_bf16 v[32:47], v[22:23], v[12:13], v[32:47]
    v_exp_f32 v58, v58
    v_cvt_pk_bf16_f32 v76, v56, v57
    v_exp_f32 v59, v59
    v_exp_f32 v60, v60
    v_cvt_pk_bf16_f32 v77, v58, v59
    v_mfma_f32_32x32x16_bf16 v[96:111], v[28:31], v[72:75], v[96:111]
    v_exp_f32 v61, v61
    ds_read_b128 v[28:31], v215 offset:35840
    v_exp_f32 v62, v62
    v_cvt_pk_bf16_f32 v78, v60, v61
    v_exp_f32 v63, v63
    s_nop 0
    v_exp_f32 v32, v32
    v_cvt_pk_bf16_f32 v79, v62, v63
    v_exp_f32 v33, v33
    v_exp_f32 v34, v34
    s_setprio 1
    v_mfma_f32_32x32x16_bf16 v[96:111], v[200:203], v[76:79], v[96:111]
    v_cvt_pk_bf16_f32 v64, v32, v33
    ds_read_b128 v[200:203], v215 offset:36608
    v_exp_f32 v35, v35
    v_exp_f32 v36, v36
    v_cvt_pk_bf16_f32 v65, v34, v35
    v_exp_f32 v37, v37
    v_exp_f32 v38, v38
    v_mfma_f32_32x32x16_bf16 v[48:63], v[24:27], v[16:19], 0
    v_cvt_pk_bf16_f32 v66, v36, v37
    v_exp_f32 v39, v39
    v_exp_f32 v40, v40
    v_cvt_pk_bf16_f32 v67, v38, v39
    s_setprio 0
    v_exp_f32 v41, v41
    v_mfma_f32_32x32x8_bf16 v[48:63], v[22:23], v[20:21], v[48:63]
    v_exp_f32 v42, v42
    v_cvt_pk_bf16_f32 v68, v40, v41
    s_waitcnt vmcnt(1) lgkmcnt(0)
    s_barrier
    s_setprio 3
    v_exp_f32 v43, v43
    v_exp_f32 v44, v44
    ds_read_b128 v[24:27], v213 offset:10240
    v_cvt_pk_bf16_f32 v69, v42, v43
    v_mfma_f32_32x32x16_bf16 v[80:95], v[28:31], v[64:67], v[80:95]
    ds_read_b64 v[22:23], v214 offset:12800
    s_add_u32 m0, s15, 151552
    s_mov_b32 s16, 49152
    s_mov_b64 exec, s[10:11]
    buffer_load_dwordx4 v206, s[64:67], s16 offen sc1 lds
    s_mov_b64 exec, -1
    v_exp_f32 v45, v45
    v_exp_f32 v46, v46
    v_cvt_pk_bf16_f32 v70, v44, v45
    v_exp_f32 v47, v47
    v_exp_f32 v48, v48
    v_cvt_pk_bf16_f32 v71, v46, v47
    v_exp_f32 v49, v49
    v_exp_f32 v50, v50
    v_mfma_f32_32x32x16_bf16 v[80:95], v[200:203], v[68:71], v[80:95]
    v_cvt_pk_bf16_f32 v72, v48, v49
    s_add_u32 m0, s15, 81920
    s_mov_b64 exec, s[10:11]
    buffer_load_dwordx4 v208, s[56:59], s23 offen lds
    s_mov_b64 exec, -1
    v_exp_f32 v51, v51
    v_exp_f32 v52, v52
    v_cvt_pk_bf16_f32 v73, v50, v51
    v_exp_f32 v53, v53
    v_exp_f32 v54, v54
    s_waitcnt lgkmcnt(1)
    v_mfma_f32_32x32x16_bf16 v[32:47], v[24:27], v[8:11], 0
    s_setprio 2
    v_cvt_pk_bf16_f32 v74, v52, v53
    v_exp_f32 v55, v55
    v_exp_f32 v56, v56
    v_cvt_pk_bf16_f32 v75, v54, v55
    s_add_u32 m0, s15, 88064
    s_mov_b64 exec, s[10:11]
    buffer_load_dwordx4 v208, s[60:63], s23 offen lds
    s_mov_b64 exec, -1
    s_add_u32 s23, s23, 128
    s_cmp_eq_u32 s23, 1280
    s_cselect_b32 s23, 0, s23
    v_exp_f32 v57, v57
    s_waitcnt lgkmcnt(0)
    v_mfma_f32_32x32x8_bf16 v[32:47], v[22:23], v[12:13], v[32:47]
    v_exp_f32 v58, v58
    v_cvt_pk_bf16_f32 v76, v56, v57
    v_exp_f32 v59, v59
    v_exp_f32 v60, v60
    v_cvt_pk_bf16_f32 v77, v58, v59
    v_mfma_f32_32x32x16_bf16 v[96:111], v[28:31], v[72:75], v[96:111]
    v_exp_f32 v61, v61
    ds_read_b128 v[28:31], v215 offset:11264
    v_exp_f32 v62, v62
    v_cvt_pk_bf16_f32 v78, v60, v61
    v_exp_f32 v63, v63
    s_nop 0
    v_exp_f32 v32, v32
    v_cvt_pk_bf16_f32 v79, v62, v63
    v_exp_f32 v33, v33
    v_exp_f32 v34, v34
    s_setprio 1
    v_mfma_f32_32x32x16_bf16 v[96:111], v[200:203], v[76:79], v[96:111]
    v_cvt_pk_bf16_f32 v64, v32, v33
    ds_read_b128 v[200:203], v215 offset:12032
    v_exp_f32 v35, v35
    v_exp_f32 v36, v36
    v_cvt_pk_bf16_f32 v65, v34, v35
    v_exp_f32 v37, v37
    v_exp_f32 v38, v38
    v_mfma_f32_32x32x16_bf16 v[48:63], v[24:27], v[16:19], 0
    v_cvt_pk_bf16_f32 v66, v36, v37
    v_exp_f32 v39, v39
    v_exp_f32 v40, v40
    v_cvt_pk_bf16_f32 v67, v38, v39
    s_setprio 0
    v_exp_f32 v41, v41
    v_mfma_f32_32x32x8_bf16 v[48:63], v[22:23], v[20:21], v[48:63]
    v_exp_f32 v42, v42
    v_cvt_pk_bf16_f32 v68, v40, v41
    s_setprio 3
    v_exp_f32 v43, v43
    v_exp_f32 v44, v44
    ds_read_b128 v[24:27], v213 offset:16384
    v_cvt_pk_bf16_f32 v69, v42, v43
    s_waitcnt lgkmcnt(2)
    v_mfma_f32_32x32x16_bf16 v[80:95], v[28:31], v[64:67], v[80:95]
    ds_read_b64 v[22:23], v214 offset:18944
    s_add_u32 m0, s15, 157696
    s_mov_b32 s16, 55296
    s_mov_b64 exec, s[10:11]
    buffer_load_dwordx4 v206, s[64:67], s16 offen sc1 lds
    s_mov_b64 exec, -1
    v_exp_f32 v45, v45
    v_exp_f32 v46, v46
    v_cvt_pk_bf16_f32 v70, v44, v45
    v_exp_f32 v47, v47
    v_exp_f32 v48, v48
    v_cvt_pk_bf16_f32 v71, v46, v47
    v_exp_f32 v49, v49
    v_exp_f32 v50, v50
    s_waitcnt lgkmcnt(2)
    v_mfma_f32_32x32x16_bf16 v[80:95], v[200:203], v[68:71], v[80:95]
    v_cvt_pk_bf16_f32 v72, v48, v49
    v_exp_f32 v51, v51
    v_exp_f32 v52, v52
    v_cvt_pk_bf16_f32 v73, v50, v51
    v_exp_f32 v53, v53
    v_exp_f32 v54, v54
    s_waitcnt lgkmcnt(1)
    v_mfma_f32_32x32x16_bf16 v[32:47], v[24:27], v[8:11], 0
    s_setprio 2
    v_cvt_pk_bf16_f32 v74, v52, v53
    v_exp_f32 v55, v55
    v_exp_f32 v56, v56
    v_cvt_pk_bf16_f32 v75, v54, v55
    v_exp_f32 v57, v57
    s_waitcnt lgkmcnt(0)
    v_mfma_f32_32x32x8_bf16 v[32:47], v[22:23], v[12:13], v[32:47]
    v_exp_f32 v58, v58
    v_cvt_pk_bf16_f32 v76, v56, v57
    v_exp_f32 v59, v59
    v_exp_f32 v60, v60
    v_cvt_pk_bf16_f32 v77, v58, v59
    v_mfma_f32_32x32x16_bf16 v[96:111], v[28:31], v[72:75], v[96:111]
    v_exp_f32 v61, v61
    ds_read_b128 v[28:31], v215 offset:17408
    v_exp_f32 v62, v62
    v_cvt_pk_bf16_f32 v78, v60, v61
    v_exp_f32 v63, v63
    s_nop 0
    v_exp_f32 v32, v32
    v_cvt_pk_bf16_f32 v79, v62, v63
    v_exp_f32 v33, v33
    v_exp_f32 v34, v34
    s_setprio 1
    v_mfma_f32_32x32x16_bf16 v[96:111], v[200:203], v[76:79], v[96:111]
    v_cvt_pk_bf16_f32 v64, v32, v33
    ds_read_b128 v[200:203], v215 offset:18176
    v_exp_f32 v35, v35
    v_exp_f32 v36, v36
    v_cvt_pk_bf16_f32 v65, v34, v35
    v_exp_f32 v37, v37
    v_exp_f32 v38, v38
    v_mfma_f32_32x32x16_bf16 v[48:63], v[24:27], v[16:19], 0
    v_cvt_pk_bf16_f32 v66, v36, v37
    v_exp_f32 v39, v39
    v_exp_f32 v40, v40
    v_cvt_pk_bf16_f32 v67, v38, v39
    s_setprio 0
    v_exp_f32 v41, v41
    v_mfma_f32_32x32x8_bf16 v[48:63], v[22:23], v[20:21], v[48:63]
    v_exp_f32 v42, v42
    v_cvt_pk_bf16_f32 v68, v40, v41
    s_waitcnt vmcnt(1) lgkmcnt(0)
    s_barrier
    s_setprio 3
    v_exp_f32 v43, v43
    v_exp_f32 v44, v44
    ds_read_b128 v[24:27], v213 offset:22528
    v_cvt_pk_bf16_f32 v69, v42, v43
    v_mfma_f32_32x32x16_bf16 v[80:95], v[28:31], v[64:67], v[80:95]
    ds_read_b64 v[22:23], v214 offset:25088
    s_add_u32 m0, s15, 133120
    s_mov_b32 s16, 61440
    s_mov_b64 exec, s[10:11]
    buffer_load_dwordx4 v206, s[64:67], s16 offen sc1 lds
    s_mov_b64 exec, -1
    v_exp_f32 v45, v45
    v_exp_f32 v46, v46
    v_cvt_pk_bf16_f32 v70, v44, v45
    v_exp_f32 v47, v47
    v_exp_f32 v48, v48
    v_cvt_pk_bf16_f32 v71, v46, v47
    s_add_u32 m0, s15, 94208
    s_mov_b64 exec, s[10:11]
    buffer_load_dwordx4 v208, s[56:59], s23 offen lds
    s_mov_b64 exec, -1
    v_exp_f32 v49, v49
    v_exp_f32 v50, v50
    v_mfma_f32_32x32x16_bf16 v[80:95], v[200:203], v[68:71], v[80:95]
    v_cvt_pk_bf16_f32 v72, v48, v49
    v_exp_f32 v51, v51
    v_exp_f32 v52, v52
    s_add_u32 m0, s15, 100352
    s_mov_b64 exec, s[10:11]
    buffer_load_dwordx4 v208, s[60:63], s23 offen lds
    s_mov_b64 exec, -1
    s_add_u32 s23, s23, 128
    s_cmp_eq_u32 s23, 1280
    s_cselect_b32 s23, 0, s23
    v_cvt_pk_bf16_f32 v73, v50, v51
    v_exp_f32 v53, v53
    v_exp_f32 v54, v54
    s_waitcnt lgkmcnt(1)
    v_mfma_f32_32x32x16_bf16 v[32:47], v[24:27], v[8:11], 0
    s_setprio 2
    v_cvt_pk_bf16_f32 v74, v52, v53
    v_exp_f32 v55, v55
    s_add_u32 m0, s15, 106496
    s_mov_b64 exec, s[10:11]
    buffer_load_dwordx4 v208, s[56:59], s23 offen lds
    s_mov_b64 exec, -1
    v_exp_f32 v56, v56
    v_cvt_pk_bf16_f32 v75, v54, v55
    v_exp_f32 v57, v57
    s_waitcnt lgkmcnt(0)
    v_mfma_f32_32x32x8_bf16 v[32:47], v[22:23], v[12:13], v[32:47]
    v_exp_f32 v58, v58
    v_cvt_pk_bf16_f32 v76, v56, v57
    s_add_u32 m0, s15, 112640
    s_mov_b64 exec, s[10:11]
    buffer_load_dwordx4 v208, s[60:63], s23 offen lds
    s_mov_b64 exec, -1
    s_add_u32 s23, s23, 128
    s_cmp_eq_u32 s23, 1280
    s_cselect_b32 s23, 0, s23
    v_exp_f32 v59, v59
    v_exp_f32 v60, v60
    v_cvt_pk_bf16_f32 v77, v58, v59
    v_mfma_f32_32x32x16_bf16 v[96:111], v[28:31], v[72:75], v[96:111]
    v_exp_f32 v61, v61
    ds_read_b128 v[28:31], v215 offset:23552
    v_exp_f32 v62, v62
    v_cvt_pk_bf16_f32 v78, v60, v61
    v_exp_f32 v63, v63
    v_exp_f32 v32, v32
    v_cvt_pk_bf16_f32 v79, v62, v63
    v_exp_f32 v33, v33
    v_exp_f32 v34, v34
    s_setprio 1
    v_mfma_f32_32x32x16_bf16 v[96:111], v[200:203], v[76:79], v[96:111]
    v_cvt_pk_bf16_f32 v64, v32, v33
    ds_read_b128 v[200:203], v215 offset:24320
    v_exp_f32 v35, v35
    v_exp_f32 v36, v36
    v_cvt_pk_bf16_f32 v65, v34, v35
    v_exp_f32 v37, v37
    v_exp_f32 v38, v38
    v_mfma_f32_32x32x16_bf16 v[48:63], v[24:27], v[16:19], 0
    v_cvt_pk_bf16_f32 v66, v36, v37
    v_exp_f32 v39, v39
    v_exp_f32 v40, v40
    v_cvt_pk_bf16_f32 v67, v38, v39
    s_setprio 0
    v_exp_f32 v41, v41
    v_mfma_f32_32x32x8_bf16 v[48:63], v[22:23], v[20:21], v[48:63]
    v_exp_f32 v42, v42
    v_cvt_pk_bf16_f32 v68, v40, v41
    s_setprio 3
    v_exp_f32 v43, v43
    v_exp_f32 v44, v44
    ds_read_b128 v[24:27], v213 offset:28672
    v_cvt_pk_bf16_f32 v69, v42, v43
    s_waitcnt lgkmcnt(2)
    v_mfma_f32_32x32x16_bf16 v[80:95], v[28:31], v[64:67], v[80:95]
    ds_read_b64 v[22:23], v214 offset:31232
    s_add_u32 m0, s15, 139264
    s_mov_b32 s16, 67584
    s_mov_b64 exec, s[10:11]
    buffer_load_dwordx4 v206, s[64:67], s16 offen sc1 lds
    s_mov_b64 exec, -1
    v_exp_f32 v45, v45
    v_exp_f32 v46, v46
    v_cvt_pk_bf16_f32 v70, v44, v45
    v_exp_f32 v47, v47
    v_exp_f32 v48, v48
    v_cvt_pk_bf16_f32 v71, v46, v47
    v_exp_f32 v49, v49
    v_exp_f32 v50, v50
    s_waitcnt lgkmcnt(2)
    v_mfma_f32_32x32x16_bf16 v[80:95], v[200:203], v[68:71], v[80:95]
    v_cvt_pk_bf16_f32 v72, v48, v49
    v_exp_f32 v51, v51
    v_exp_f32 v52, v52
    v_cvt_pk_bf16_f32 v73, v50, v51
    v_exp_f32 v53, v53
    v_exp_f32 v54, v54
    s_waitcnt lgkmcnt(1)
    v_mfma_f32_32x32x16_bf16 v[32:47], v[24:27], v[8:11], 0
    s_setprio 2
    v_cvt_pk_bf16_f32 v74, v52, v53
    v_exp_f32 v55, v55
    v_exp_f32 v56, v56
    v_cvt_pk_bf16_f32 v75, v54, v55
    v_exp_f32 v57, v57
    s_waitcnt lgkmcnt(0)
    v_mfma_f32_32x32x8_bf16 v[32:47], v[22:23], v[12:13], v[32:47]
    v_exp_f32 v58, v58
    v_cvt_pk_bf16_f32 v76, v56, v57
    v_exp_f32 v59, v59
    v_exp_f32 v60, v60
    v_cvt_pk_bf16_f32 v77, v58, v59
    v_mfma_f32_32x32x16_bf16 v[96:111], v[28:31], v[72:75], v[96:111]
    v_exp_f32 v61, v61
    ds_read_b128 v[28:31], v215 offset:29696
    v_exp_f32 v62, v62
    v_cvt_pk_bf16_f32 v78, v60, v61
    v_exp_f32 v63, v63
    s_nop 0
    v_exp_f32 v32, v32
    v_cvt_pk_bf16_f32 v79, v62, v63
    v_exp_f32 v33, v33
    v_exp_f32 v34, v34
    s_setprio 1
    v_mfma_f32_32x32x16_bf16 v[96:111], v[200:203], v[76:79], v[96:111]
    v_cvt_pk_bf16_f32 v64, v32, v33
    ds_read_b128 v[200:203], v215 offset:30464
    v_exp_f32 v35, v35
    v_exp_f32 v36, v36
    v_cvt_pk_bf16_f32 v65, v34, v35
    v_exp_f32 v37, v37
    v_exp_f32 v38, v38
    v_mfma_f32_32x32x16_bf16 v[48:63], v[24:27], v[16:19], 0
    v_cvt_pk_bf16_f32 v66, v36, v37
    v_exp_f32 v39, v39
    v_exp_f32 v40, v40
    v_cvt_pk_bf16_f32 v67, v38, v39
    s_setprio 0
    v_exp_f32 v41, v41
    v_mfma_f32_32x32x8_bf16 v[48:63], v[22:23], v[20:21], v[48:63]
    v_exp_f32 v42, v42
    v_cvt_pk_bf16_f32 v68, v40, v41
    s_waitcnt vmcnt(1) lgkmcnt(0)
    s_barrier
    s_setprio 3
    v_exp_f32 v43, v43
    v_exp_f32 v44, v44
    ds_read_b128 v[24:27], v213 offset:34816
    v_cvt_pk_bf16_f32 v69, v42, v43
    v_mfma_f32_32x32x16_bf16 v[80:95], v[28:31], v[64:67], v[80:95]
    ds_read_b64 v[22:23], v214 offset:37376
    s_add_u32 m0, s15, 145408
    s_mov_b32 s16, 73728
    s_mov_b64 exec, s[10:11]
    buffer_load_dwordx4 v206, s[64:67], s16 offen sc1 lds
    s_mov_b64 exec, -1
    v_exp_f32 v45, v45
    v_exp_f32 v46, v46
    v_cvt_pk_bf16_f32 v70, v44, v45
    v_exp_f32 v47, v47
    v_exp_f32 v48, v48
    v_cvt_pk_bf16_f32 v71, v46, v47
    v_exp_f32 v49, v49
    v_exp_f32 v50, v50
    v_mfma_f32_32x32x16_bf16 v[80:95], v[200:203], v[68:71], v[80:95]
    v_cvt_pk_bf16_f32 v72, v48, v49
    s_add_u32 m0, s15, 118784
    s_mov_b64 exec, s[10:11]
    buffer_load_dwordx4 v208, s[56:59], s23 offen lds
    s_mov_b64 exec, -1
    v_exp_f32 v51, v51
    v_exp_f32 v52, v52
    v_cvt_pk_bf16_f32 v73, v50, v51
    v_exp_f32 v53, v53
    v_exp_f32 v54, v54
    s_waitcnt lgkmcnt(1)
    v_mfma_f32_32x32x16_bf16 v[32:47], v[24:27], v[8:11], 0
    s_setprio 2
    v_cvt_pk_bf16_f32 v74, v52, v53
    v_exp_f32 v55, v55
    v_exp_f32 v56, v56
    v_cvt_pk_bf16_f32 v75, v54, v55
    s_add_u32 m0, s15, 124928
    s_mov_b64 exec, s[10:11]
    buffer_load_dwordx4 v208, s[60:63], s23 offen lds
    s_mov_b64 exec, -1
    s_add_u32 s23, s23, 128
    s_cmp_eq_u32 s23, 1280
    s_cselect_b32 s23, 0, s23
    v_exp_f32 v57, v57
    s_waitcnt lgkmcnt(0)
    v_mfma_f32_32x32x8_bf16 v[32:47], v[22:23], v[12:13], v[32:47]
    v_exp_f32 v58, v58
    v_cvt_pk_bf16_f32 v76, v56, v57
    v_exp_f32 v59, v59
    v_exp_f32 v60, v60
    v_cvt_pk_bf16_f32 v77, v58, v59
    v_mfma_f32_32x32x16_bf16 v[96:111], v[28:31], v[72:75], v[96:111]
    v_exp_f32 v61, v61
    ds_read_b128 v[28:31], v215 offset:35840
    v_exp_f32 v62, v62
    v_cvt_pk_bf16_f32 v78, v60, v61
    v_exp_f32 v63, v63
    s_nop 0
    v_exp_f32 v32, v32
    v_cvt_pk_bf16_f32 v79, v62, v63
    v_exp_f32 v33, v33
    v_exp_f32 v34, v34
    s_setprio 1
    v_mfma_f32_32x32x16_bf16 v[96:111], v[200:203], v[76:79], v[96:111]
    v_cvt_pk_bf16_f32 v64, v32, v33
    ds_read_b128 v[200:203], v215 offset:36608
    v_exp_f32 v35, v35
    v_exp_f32 v36, v36
    v_cvt_pk_bf16_f32 v65, v34, v35
    v_exp_f32 v37, v37
    v_exp_f32 v38, v38
    v_mfma_f32_32x32x16_bf16 v[48:63], v[24:27], v[16:19], 0
    v_cvt_pk_bf16_f32 v66, v36, v37
    v_exp_f32 v39, v39
    v_exp_f32 v40, v40
    v_cvt_pk_bf16_f32 v67, v38, v39
    s_setprio 0
    v_exp_f32 v41, v41
    v_mfma_f32_32x32x8_bf16 v[48:63], v[22:23], v[20:21], v[48:63]
    v_exp_f32 v42, v42
    v_cvt_pk_bf16_f32 v68, v40, v41
    s_setprio 3
    v_exp_f32 v43, v43
    v_exp_f32 v44, v44
    ds_read_b128 v[24:27], v213 offset:10240
    v_cvt_pk_bf16_f32 v69, v42, v43
    s_waitcnt lgkmcnt(2)
    v_mfma_f32_32x32x16_bf16 v[80:95], v[28:31], v[64:67], v[80:95]
    ds_read_b64 v[22:23], v214 offset:12800
    s_add_u32 m0, s15, 151552
    s_mov_b32 s16, 79872
    s_mov_b64 exec, s[10:11]
    buffer_load_dwordx4 v206, s[64:67], s16 offen sc1 lds
    s_mov_b64 exec, -1
    v_exp_f32 v45, v45
    v_exp_f32 v46, v46
    v_cvt_pk_bf16_f32 v70, v44, v45
    v_exp_f32 v47, v47
    v_exp_f32 v48, v48
    v_cvt_pk_bf16_f32 v71, v46, v47
    v_exp_f32 v49, v49
    v_exp_f32 v50, v50
    s_waitcnt lgkmcnt(2)
    v_mfma_f32_32x32x16_bf16 v[80:95], v[200:203], v[68:71], v[80:95]
    v_cvt_pk_bf16_f32 v72, v48, v49
    v_exp_f32 v51, v51
    v_exp_f32 v52, v52
    v_cvt_pk_bf16_f32 v73, v50, v51
    v_exp_f32 v53, v53
    v_exp_f32 v54, v54
    v_mov_b32 v240, -1
    v_mov_b32 v241, -1
    v_mov_b32 v242, -1
    v_mov_b32 v243, -1
    buffer_store_dwordx4 v[240:243], v14, s[64:67], 0 offen sc1
    s_mov_b32 exec_hi, 0
    buffer_store_dwordx2 v[240:241], v15, s[64:67], 0 offen sc1
    s_mov_b32 exec_hi, -1
    s_waitcnt lgkmcnt(1)
    v_mfma_f32_32x32x16_bf16 v[32:47], v[24:27], v[8:11], 0
    s_setprio 2
    v_cvt_pk_bf16_f32 v74, v52, v53
    v_exp_f32 v55, v55
    v_exp_f32 v56, v56
    v_cvt_pk_bf16_f32 v75, v54, v55
    v_exp_f32 v57, v57
    s_waitcnt lgkmcnt(0)
    v_mfma_f32_32x32x8_bf16 v[32:47], v[22:23], v[12:13], v[32:47]
    v_exp_f32 v58, v58
    v_cvt_pk_bf16_f32 v76, v56, v57
    v_exp_f32 v59, v59
    v_exp_f32 v60, v60
    v_cvt_pk_bf16_f32 v77, v58, v59
    v_mfma_f32_32x32x16_bf16 v[96:111], v[28:31], v[72:75], v[96:111]
    v_exp_f32 v61, v61
    ds_read_b128 v[28:31], v215 offset:11264
    v_exp_f32 v62, v62
    v_cvt_pk_bf16_f32 v78, v60, v61
    v_exp_f32 v63, v63
    s_nop 0
    v_exp_f32 v32, v32
    v_cvt_pk_bf16_f32 v79, v62, v63
    v_exp_f32 v33, v33
    v_exp_f32 v34, v34
    s_setprio 1
    v_mfma_f32_32x32x16_bf16 v[96:111], v[200:203], v[76:79], v[96:111]
    v_cvt_pk_bf16_f32 v64, v32, v33
    ds_read_b128 v[200:203], v215 offset:12032
    v_exp_f32 v35, v35
    v_exp_f32 v36, v36
    v_cvt_pk_bf16_f32 v65, v34, v35
    v_exp_f32 v37, v37
    v_exp_f32 v38, v38
    v_mfma_f32_32x32x16_bf16 v[48:63], v[24:27], v[16:19], 0
    v_cvt_pk_bf16_f32 v66, v36, v37
    v_exp_f32 v39, v39
    v_exp_f32 v40, v40
    v_cvt_pk_bf16_f32 v67, v38, v39
    s_setprio 0
    v_exp_f32 v41, v41
    v_mfma_f32_32x32x8_bf16 v[48:63], v[22:23], v[20:21], v[48:63]
    v_exp_f32 v42, v42
    v_cvt_pk_bf16_f32 v68, v40, v41
    s_waitcnt vmcnt(3) lgkmcnt(0)
    s_barrier
    s_setprio 3
    v_exp_f32 v43, v43
    v_exp_f32 v44, v44
    ds_read_b128 v[24:27], v213 offset:16384
    v_cvt_pk_bf16_f32 v69, v42, v43
    v_mfma_f32_32x32x16_bf16 v[80:95], v[28:31], v[64:67], v[80:95]
    ds_read_b64 v[22:23], v214 offset:18944
    s_add_u32 m0, s15, 157696
    s_mov_b32 s16, 86016
    s_mov_b64 exec, s[10:11]
    buffer_load_dwordx4 v206, s[64:67], s16 offen sc1 lds
    s_mov_b64 exec, -1
    v_exp_f32 v45, v45
    v_exp_f32 v46, v46
    v_cvt_pk_bf16_f32 v70, v44, v45
    v_exp_f32 v47, v47
    v_exp_f32 v48, v48
    v_cvt_pk_bf16_f32 v71, v46, v47
    s_add_u32 m0, s15, 81920
    s_mov_b64 exec, s[10:11]
    buffer_load_dwordx4 v208, s[56:59], s23 offen lds
    s_mov_b64 exec, -1
    v_exp_f32 v49, v49
    v_exp_f32 v50, v50
    v_mfma_f32_32x32x16_bf16 v[80:95], v[200:203], v[68:71], v[80:95]
    v_cvt_pk_bf16_f32 v72, v48, v49
    v_exp_f32 v51, v51
    v_exp_f32 v52, v52
    s_add_u32 m0, s15, 88064
    s_mov_b64 exec, s[10:11]
    buffer_load_dwordx4 v208, s[60:63], s23 offen lds
    s_mov_b64 exec, -1
    s_add_u32 s23, s23, 128
    s_cmp_eq_u32 s23, 1280
    s_cselect_b32 s23, 0, s23
    v_cvt_pk_bf16_f32 v73, v50, v51
    v_exp_f32 v53, v53
    v_exp_f32 v54, v54
    s_waitcnt lgkmcnt(1)
    v_mfma_f32_32x32x16_bf16 v[32:47], v[24:27], v[8:11], 0
    s_setprio 2
    v_cvt_pk_bf16_f32 v74, v52, v53
    v_exp_f32 v55, v55
    s_add_u32 m0, s15, 94208
    s_mov_b64 exec, s[10:11]
    buffer_load_dwordx4 v208, s[56:59], s23 offen lds
    s_mov_b64 exec, -1
    v_exp_f32 v56, v56
    v_cvt_pk_bf16_f32 v75, v54, v55
    v_exp_f32 v57, v57
    s_waitcnt lgkmcnt(0)
    v_mfma_f32_32x32x8_bf16 v[32:47], v[22:23], v[12:13], v[32:47]
    v_exp_f32 v58, v58
    v_cvt_pk_bf16_f32 v76, v56, v57
    s_add_u32 m0, s15, 100352
    s_mov_b64 exec, s[10:11]
    buffer_load_dwordx4 v208, s[60:63], s23 offen lds
    s_mov_b64 exec, -1
    s_add_u32 s23, s23, 128
    s_cmp_eq_u32 s23, 1280
    s_cselect_b32 s23, 0, s23
    v_exp_f32 v59, v59
    v_exp_f32 v60, v60
    v_cvt_pk_bf16_f32 v77, v58, v59
    v_mfma_f32_32x32x16_bf16 v[96:111], v[28:31], v[72:75], v[96:111]
    v_exp_f32 v61, v61
    ds_read_b128 v[28:31], v215 offset:17408
    v_exp_f32 v62, v62
    v_cvt_pk_bf16_f32 v78, v60, v61
    v_exp_f32 v63, v63
    v_exp_f32 v32, v32
    v_cvt_pk_bf16_f32 v79, v62, v63
    v_exp_f32 v33, v33
    v_exp_f32 v34, v34
    s_setprio 1
    v_mfma_f32_32x32x16_bf16 v[96:111], v[200:203], v[76:79], v[96:111]
    v_cvt_pk_bf16_f32 v64, v32, v33
    ds_read_b128 v[200:203], v215 offset:18176
    v_exp_f32 v35, v35
    v_exp_f32 v36, v36
    v_cvt_pk_bf16_f32 v65, v34, v35
    v_exp_f32 v37, v37
    v_exp_f32 v38, v38
    v_mfma_f32_32x32x16_bf16 v[48:63], v[24:27], v[16:19], 0
    v_cvt_pk_bf16_f32 v66, v36, v37
    v_exp_f32 v39, v39
    v_exp_f32 v40, v40
    v_cvt_pk_bf16_f32 v67, v38, v39
    s_setprio 0
    v_exp_f32 v41, v41
    v_mfma_f32_32x32x8_bf16 v[48:63], v[22:23], v[20:21], v[48:63]
    v_exp_f32 v42, v42
    v_cvt_pk_bf16_f32 v68, v40, v41
    s_setprio 3
    v_exp_f32 v43, v43
    v_exp_f32 v44, v44
    ds_read_b128 v[24:27], v213 offset:22528
    v_cvt_pk_bf16_f32 v69, v42, v43
    s_waitcnt lgkmcnt(2)
    v_mfma_f32_32x32x16_bf16 v[80:95], v[28:31], v[64:67], v[80:95]
    ds_read_b64 v[22:23], v214 offset:25088
    s_add_u32 m0, s15, 133120
    s_mov_b32 s16, 92160
    s_mov_b64 exec, s[10:11]
    buffer_load_dwordx4 v206, s[64:67], s16 offen sc1 lds
    s_mov_b64 exec, -1
    v_exp_f32 v45, v45
    v_exp_f32 v46, v46
    v_cvt_pk_bf16_f32 v70, v44, v45
    v_exp_f32 v47, v47
    v_exp_f32 v48, v48
    v_cvt_pk_bf16_f32 v71, v46, v47
    v_exp_f32 v49, v49
    v_exp_f32 v50, v50
    s_waitcnt lgkmcnt(2)
    v_mfma_f32_32x32x16_bf16 v[80:95], v[200:203], v[68:71], v[80:95]
    v_cvt_pk_bf16_f32 v72, v48, v49
    v_exp_f32 v51, v51
    v_exp_f32 v52, v52
    v_cvt_pk_bf16_f32 v73, v50, v51
    v_exp_f32 v53, v53
    v_exp_f32 v54, v54
    s_waitcnt lgkmcnt(1)
    v_mfma_f32_32x32x16_bf16 v[32:47], v[24:27], v[8:11], 0
    s_setprio 2
    v_cvt_pk_bf16_f32 v74, v52, v53
    v_exp_f32 v55, v55
    v_exp_f32 v56, v56
    v_cvt_pk_bf16_f32 v75, v54, v55
    v_exp_f32 v57, v57
    s_waitcnt lgkmcnt(0)
    v_mfma_f32_32x32x8_bf16 v[32:47], v[22:23], v[12:13], v[32:47]
    v_exp_f32 v58, v58
    v_cvt_pk_bf16_f32 v76, v56, v57
    v_exp_f32 v59, v59
    v_exp_f32 v60, v60
    v_cvt_pk_bf16_f32 v77, v58, v59
    v_mfma_f32_32x32x16_bf16 v[96:111], v[28:31], v[72:75], v[96:111]
    v_exp_f32 v61, v61
    ds_read_b128 v[28:31], v215 offset:23552
    v_exp_f32 v62, v62
    v_cvt_pk_bf16_f32 v78, v60, v61
    v_exp_f32 v63, v63
    s_nop 0
    v_exp_f32 v32, v32
    v_cvt_pk_bf16_f32 v79, v62, v63
    v_exp_f32 v33, v33
    v_exp_f32 v34, v34
    s_setprio 1
    v_mfma_f32_32x32x16_bf16 v[96:111], v[200:203], v[76:79], v[96:111]
    v_cvt_pk_bf16_f32 v64, v32, v33
    ds_read_b128 v[200:203], v215 offset:24320
    v_exp_f32 v35, v35
    v_exp_f32 v36, v36
    v_cvt_pk_bf16_f32 v65, v34, v35
    v_exp_f32 v37, v37
    v_exp_f32 v38, v38
    v_mfma_f32_32x32x16_bf16 v[48:63], v[24:27], v[16:19], 0
    v_cvt_pk_bf16_f32 v66, v36, v37
    v_exp_f32 v39, v39
    v_exp_f32 v40, v40
    v_cvt_pk_bf16_f32 v67, v38, v39
    s_setprio 0
    v_exp_f32 v41, v41
    v_mfma_f32_32x32x8_bf16 v[48:63], v[22:23], v[20:21], v[48:63]
    v_exp_f32 v42, v42
    v_cvt_pk_bf16_f32 v68, v40, v41
    s_waitcnt vmcnt(1) lgkmcnt(0)
    s_barrier
    s_setprio 3
    v_exp_f32 v43, v43
    v_exp_f32 v44, v44
    ds_read_b128 v[24:27], v213 offset:28672
    v_cvt_pk_bf16_f32 v69, v42, v43
    v_mfma_f32_32x32x16_bf16 v[80:95], v[28:31], v[64:67], v[80:95]
    ds_read_b64 v[22:23], v214 offset:31232
    s_add_u32 m0, s15, 139264
    s_mov_b32 s16, 98304
    s_mov_b64 exec, s[10:11]
    buffer_load_dwordx4 v206, s[64:67], s16 offen sc1 lds
    s_mov_b64 exec, -1
    v_exp_f32 v45, v45
    v_exp_f32 v46, v46
    v_cvt_pk_bf16_f32 v70, v44, v45
    v_exp_f32 v47, v47
    v_exp_f32 v48, v48
    v_cvt_pk_bf16_f32 v71, v46, v47
    v_exp_f32 v49, v49
    v_exp_f32 v50, v50
    v_mfma_f32_32x32x16_bf16 v[80:95], v[200:203], v[68:71], v[80:95]
    v_cvt_pk_bf16_f32 v72, v48, v49
    v_exp_f32 v51, v51
    v_exp_f32 v52, v52
    v_cvt_pk_bf16_f32 v73, v50, v51
    v_exp_f32 v53, v53
    v_exp_f32 v54, v54
    s_waitcnt lgkmcnt(1)
    v_mfma_f32_32x32x16_bf16 v[32:47], v[24:27], v[8:11], 0
    s_setprio 2
    v_cvt_pk_bf16_f32 v74, v52, v53
    v_exp_f32 v55, v55
    v_exp_f32 v56, v56
    v_cvt_pk_bf16_f32 v75, v54, v55
    v_exp_f32 v57, v57
    s_waitcnt lgkmcnt(0)
    v_mfma_f32_32x32x8_bf16 v[32:47], v[22:23], v[12:13], v[32:47]
    v_exp_f32 v58, v58
    v_cvt_pk_bf16_f32 v76, v56, v57
    v_exp_f32 v59, v59
    v_exp_f32 v60, v60
    v_cvt_pk_bf16_f32 v77, v58, v59
    v_mfma_f32_32x32x16_bf16 v[96:111], v[28:31], v[72:75], v[96:111]
    v_exp_f32 v61, v61
    ds_read_b128 v[28:31], v215 offset:29696
    v_exp_f32 v62, v62
    v_cvt_pk_bf16_f32 v78, v60, v61
    v_exp_f32 v63, v63
    s_nop 0
    v_exp_f32 v32, v32
    v_cvt_pk_bf16_f32 v79, v62, v63
    v_exp_f32 v33, v33
    v_exp_f32 v34, v34
    s_setprio 1
    v_mfma_f32_32x32x16_bf16 v[96:111], v[200:203], v[76:79], v[96:111]
    v_cvt_pk_bf16_f32 v64, v32, v33
    ds_read_b128 v[200:203], v215 offset:30464
    v_exp_f32 v35, v35
    v_exp_f32 v36, v36
    v_cvt_pk_bf16_f32 v65, v34, v35
    v_exp_f32 v37, v37
    v_exp_f32 v38, v38
    v_mfma_f32_32x32x16_bf16 v[48:63], v[24:27], v[16:19], 0
    v_cvt_pk_bf16_f32 v66, v36, v37
    v_exp_f32 v39, v39
    v_exp_f32 v40, v40
    v_cvt_pk_bf16_f32 v67, v38, v39
    s_setprio 0
    v_exp_f32 v41, v41
    v_mfma_f32_32x32x8_bf16 v[48:63], v[22:23], v[20:21], v[48:63]
    v_exp_f32 v42, v42
    v_cvt_pk_bf16_f32 v68, v40, v41
    s_setprio 3
    v_exp_f32 v43, v43
    v_exp_f32 v44, v44
    ds_read_b128 v[24:27], v213 offset:34816
    v_cvt_pk_bf16_f32 v69, v42, v43
    s_waitcnt lgkmcnt(2)
    v_mfma_f32_32x32x16_bf16 v[80:95], v[28:31], v[64:67], v[80:95]
    ds_read_b64 v[22:23], v214 offset:37376
    s_add_u32 m0, s15, 145408
    s_mov_b32 s16, 104448
    s_mov_b64 exec, s[10:11]
    buffer_load_dwordx4 v206, s[64:67], s16 offen sc1 lds
    s_mov_b64 exec, -1
    v_exp_f32 v45, v45
    v_exp_f32 v46, v46
    v_cvt_pk_bf16_f32 v70, v44, v45
    v_exp_f32 v47, v47
    v_exp_f32 v48, v48
    v_cvt_pk_bf16_f32 v71, v46, v47
    v_exp_f32 v49, v49
    v_exp_f32 v50, v50
    s_waitcnt lgkmcnt(2)
    v_mfma_f32_32x32x16_bf16 v[80:95], v[200:203], v[68:71], v[80:95]
    v_cvt_pk_bf16_f32 v72, v48, v49
    v_exp_f32 v51, v51
    v_exp_f32 v52, v52
    v_cvt_pk_bf16_f32 v73, v50, v51
    v_exp_f32 v53, v53
    v_exp_f32 v54, v54
    s_waitcnt lgkmcnt(1)
    v_mfma_f32_32x32x16_bf16 v[32:47], v[24:27], v[8:11], 0
    s_setprio 2
    v_cvt_pk_bf16_f32 v74, v52, v53
    v_exp_f32 v55, v55
    v_exp_f32 v56, v56
    v_cvt_pk_bf16_f32 v75, v54, v55
    v_exp_f32 v57, v57
    s_waitcnt lgkmcnt(0)
    v_mfma_f32_32x32x8_bf16 v[32:47], v[22:23], v[12:13], v[32:47]
    v_exp_f32 v58, v58
    v_cvt_pk_bf16_f32 v76, v56, v57
    v_exp_f32 v59, v59
    v_exp_f32 v60, v60
    v_cvt_pk_bf16_f32 v77, v58, v59
    v_mfma_f32_32x32x16_bf16 v[96:111], v[28:31], v[72:75], v[96:111]
    v_exp_f32 v61, v61
    ds_read_b128 v[28:31], v215 offset:35840
    v_exp_f32 v62, v62
    v_cvt_pk_bf16_f32 v78, v60, v61
    v_exp_f32 v63, v63
    s_nop 0
    v_exp_f32 v32, v32
    v_cvt_pk_bf16_f32 v79, v62, v63
    v_exp_f32 v33, v33
    v_exp_f32 v34, v34
    s_setprio 1
    v_mfma_f32_32x32x16_bf16 v[96:111], v[200:203], v[76:79], v[96:111]
    v_cvt_pk_bf16_f32 v64, v32, v33
    ds_read_b128 v[200:203], v215 offset:36608
    v_exp_f32 v35, v35
    v_exp_f32 v36, v36
    v_cvt_pk_bf16_f32 v65, v34, v35
    v_exp_f32 v37, v37
    v_exp_f32 v38, v38
    v_mfma_f32_32x32x16_bf16 v[48:63], v[24:27], v[16:19], 0
    v_cvt_pk_bf16_f32 v66, v36, v37
    v_exp_f32 v39, v39
    v_exp_f32 v40, v40
    v_cvt_pk_bf16_f32 v67, v38, v39
    s_setprio 0
    v_exp_f32 v41, v41
    v_mfma_f32_32x32x8_bf16 v[48:63], v[22:23], v[20:21], v[48:63]
    v_exp_f32 v42, v42
    v_cvt_pk_bf16_f32 v68, v40, v41
    s_waitcnt vmcnt(1) lgkmcnt(0)
    s_barrier
    s_setprio 3
    v_exp_f32 v43, v43
    v_exp_f32 v44, v44
    ds_read_b128 v[24:27], v213 offset:10240
    v_cvt_pk_bf16_f32 v69, v42, v43
    v_mfma_f32_32x32x16_bf16 v[80:95], v[28:31], v[64:67], v[80:95]
    ds_read_b64 v[22:23], v214 offset:12800
    s_add_u32 m0, s15, 151552
    s_mov_b32 s16, 110592
    s_mov_b64 exec, s[10:11]
    buffer_load_dwordx4 v206, s[64:67], s16 offen sc1 lds
    s_mov_b64 exec, -1
    v_exp_f32 v45, v45
    v_exp_f32 v46, v46
    v_cvt_pk_bf16_f32 v70, v44, v45
    v_exp_f32 v47, v47
    v_exp_f32 v48, v48
    v_cvt_pk_bf16_f32 v71, v46, v47
    v_exp_f32 v49, v49
    v_exp_f32 v50, v50
    v_mfma_f32_32x32x16_bf16 v[80:95], v[200:203], v[68:71], v[80:95]
    v_cvt_pk_bf16_f32 v72, v48, v49
    v_exp_f32 v51, v51
    v_exp_f32 v52, v52
    v_cvt_pk_bf16_f32 v73, v50, v51
    v_exp_f32 v53, v53
    v_exp_f32 v54, v54
    s_waitcnt lgkmcnt(1)
    v_mfma_f32_32x32x16_bf16 v[32:47], v[24:27], v[8:11], 0
    s_setprio 2
    v_cvt_pk_bf16_f32 v74, v52, v53
    v_exp_f32 v55, v55
    v_exp_f32 v56, v56
    v_cvt_pk_bf16_f32 v75, v54, v55
    v_exp_f32 v57, v57
    s_waitcnt lgkmcnt(0)
    v_mfma_f32_32x32x8_bf16 v[32:47], v[22:23], v[12:13], v[32:47]
    v_exp_f32 v58, v58
    v_cvt_pk_bf16_f32 v76, v56, v57
    v_exp_f32 v59, v59
    v_exp_f32 v60, v60
    v_cvt_pk_bf16_f32 v77, v58, v59
    v_mfma_f32_32x32x16_bf16 v[96:111], v[28:31], v[72:75], v[96:111]
    v_exp_f32 v61, v61
    ds_read_b128 v[28:31], v215 offset:11264
    v_exp_f32 v62, v62
    v_cvt_pk_bf16_f32 v78, v60, v61
    v_exp_f32 v63, v63
    s_nop 0
    v_exp_f32 v32, v32
    v_cvt_pk_bf16_f32 v79, v62, v63
    v_exp_f32 v33, v33
    v_exp_f32 v34, v34
    s_setprio 1
    v_mfma_f32_32x32x16_bf16 v[96:111], v[200:203], v[76:79], v[96:111]
    v_cvt_pk_bf16_f32 v64, v32, v33
    ds_read_b128 v[200:203], v215 offset:12032
    v_exp_f32 v35, v35
    v_exp_f32 v36, v36
    v_cvt_pk_bf16_f32 v65, v34, v35
    v_exp_f32 v37, v37
    v_exp_f32 v38, v38
    v_mfma_f32_32x32x16_bf16 v[48:63], v[24:27], v[16:19], 0
    v_cvt_pk_bf16_f32 v66, v36, v37
    v_exp_f32 v39, v39
    v_exp_f32 v40, v40
    v_cvt_pk_bf16_f32 v67, v38, v39
    s_setprio 0
    v_exp_f32 v41, v41
    v_mfma_f32_32x32x8_bf16 v[48:63], v[22:23], v[20:21], v[48:63]
    v_exp_f32 v42, v42
    v_cvt_pk_bf16_f32 v68, v40, v41
    s_setprio 3
    v_exp_f32 v43, v43
    v_exp_f32 v44, v44
    ds_read_b128 v[24:27], v213 offset:16384
    v_cvt_pk_bf16_f32 v69, v42, v43
    s_waitcnt lgkmcnt(2)
    v_mfma_f32_32x32x16_bf16 v[80:95], v[28:31], v[64:67], v[80:95]
    ds_read_b64 v[22:23], v214 offset:18944
    s_add_u32 m0, s15, 157696
    s_mov_b32 s16, 116736
    s_mov_b64 exec, s[10:11]
    buffer_load_dwordx4 v206, s[64:67], s16 offen sc1 lds
    s_mov_b64 exec, -1
    v_exp_f32 v45, v45
    v_exp_f32 v46, v46
    v_cvt_pk_bf16_f32 v70, v44, v45
    v_exp_f32 v47, v47
    v_exp_f32 v48, v48
    v_cvt_pk_bf16_f32 v71, v46, v47
    v_exp_f32 v49, v49
    v_exp_f32 v50, v50
    s_waitcnt lgkmcnt(2)
    v_mfma_f32_32x32x16_bf16 v[80:95], v[200:203], v[68:71], v[80:95]
    v_cvt_pk_bf16_f32 v72, v48, v49
    v_exp_f32 v51, v51
    v_exp_f32 v52, v52
    v_cvt_pk_bf16_f32 v73, v50, v51
    v_exp_f32 v53, v53
    v_exp_f32 v54, v54
    s_waitcnt lgkmcnt(1)
    v_mfma_f32_32x32x16_bf16 v[32:47], v[24:27], v[8:11], 0
    s_setprio 2
    v_cvt_pk_bf16_f32 v74, v52, v53
    v_exp_f32 v55, v55
    v_exp_f32 v56, v56
    v_cvt_pk_bf16_f32 v75, v54, v55
    v_exp_f32 v57, v57
    s_waitcnt lgkmcnt(0)
    v_mfma_f32_32x32x8_bf16 v[32:47], v[22:23], v[12:13], v[32:47]
    v_exp_f32 v58, v58
    v_cvt_pk_bf16_f32 v76, v56, v57
    v_exp_f32 v59, v59
    v_exp_f32 v60, v60
    v_cvt_pk_bf16_f32 v77, v58, v59
    v_mfma_f32_32x32x16_bf16 v[96:111], v[28:31], v[72:75], v[96:111]
    v_exp_f32 v61, v61
    ds_read_b128 v[28:31], v215 offset:17408
    v_exp_f32 v62, v62
    v_cvt_pk_bf16_f32 v78, v60, v61
    v_exp_f32 v63, v63
    s_nop 0
    v_exp_f32 v32, v32
    v_cvt_pk_bf16_f32 v79, v62, v63
    v_exp_f32 v33, v33
    v_exp_f32 v34, v34
    s_setprio 1
    v_mfma_f32_32x32x16_bf16 v[96:111], v[200:203], v[76:79], v[96:111]
    v_cvt_pk_bf16_f32 v64, v32, v33
    ds_read_b128 v[200:203], v215 offset:18176
    v_exp_f32 v35, v35
    v_exp_f32 v36, v36
    v_cvt_pk_bf16_f32 v65, v34, v35
    v_exp_f32 v37, v37
    v_exp_f32 v38, v38
    v_mfma_f32_32x32x16_bf16 v[48:63], v[24:27], v[16:19], 0
    v_cvt_pk_bf16_f32 v66, v36, v37
    v_exp_f32 v39, v39
    v_exp_f32 v40, v40
    v_cvt_pk_bf16_f32 v67, v38, v39
    s_setprio 0
    v_exp_f32 v41, v41
    v_mfma_f32_32x32x8_bf16 v[48:63], v[22:23], v[20:21], v[48:63]
    v_exp_f32 v42, v42
    v_cvt_pk_bf16_f32 v68, v40, v41
    s_waitcnt vmcnt(1) lgkmcnt(0)
    s_barrier
    v_exp_f32 v43, v43
    v_exp_f32 v44, v44
    ds_read_b128 v[24:27], v213 offset:22528
    v_cvt_pk_bf16_f32 v69, v42, v43
    v_mfma_f32_32x32x16_bf16 v[80:95], v[28:31], v[64:67], v[80:95]
    ds_read_b64 v[22:23], v214 offset:25088
    s_add_u32 m0, s15, 133120
    s_mov_b32 s16, 122880
    s_mov_b64 exec, s[10:11]
    buffer_load_dwordx4 v206, s[64:67], s16 offen sc1 lds
    s_mov_b64 exec, -1
    v_exp_f32 v45, v45
    v_exp_f32 v46, v46
    v_cvt_pk_bf16_f32 v70, v44, v45
    v_exp_f32 v47, v47
    v_exp_f32 v48, v48
    v_cvt_pk_bf16_f32 v71, v46, v47
    v_exp_f32 v49, v49
    v_exp_f32 v50, v50
    v_mfma_f32_32x32x16_bf16 v[80:95], v[200:203], v[68:71], v[80:95]
    v_cvt_pk_bf16_f32 v72, v48, v49
    v_exp_f32 v51, v51
    v_exp_f32 v52, v52
    v_cvt_pk_bf16_f32 v73, v50, v51
    v_exp_f32 v53, v53
    v_exp_f32 v54, v54
    s_waitcnt lgkmcnt(1)
    v_mfma_f32_32x32x16_bf16 v[32:47], v[24:27], v[8:11], 0
    v_cvt_pk_bf16_f32 v74, v52, v53
    v_exp_f32 v55, v55
    v_exp_f32 v56, v56
    v_cvt_pk_bf16_f32 v75, v54, v55
    v_exp_f32 v57, v57
    s_waitcnt lgkmcnt(0)
    v_mfma_f32_32x32x8_bf16 v[32:47], v[22:23], v[12:13], v[32:47]
    v_exp_f32 v58, v58
    v_cvt_pk_bf16_f32 v76, v56, v57
    v_exp_f32 v59, v59
    v_exp_f32 v60, v60
    v_cvt_pk_bf16_f32 v77, v58, v59
    v_mfma_f32_32x32x16_bf16 v[96:111], v[28:31], v[72:75], v[96:111]
    v_exp_f32 v61, v61
    ds_read_b128 v[28:31], v215 offset:23552
    v_exp_f32 v62, v62
    v_cvt_pk_bf16_f32 v78, v60, v61
    v_exp_f32 v63, v63
    s_nop 0
    v_exp_f32 v32, v32
    v_cvt_pk_bf16_f32 v79, v62, v63
    v_exp_f32 v33, v33
    v_exp_f32 v34, v34
    v_mfma_f32_32x32x16_bf16 v[96:111], v[200:203], v[76:79], v[96:111]
    v_cvt_pk_bf16_f32 v64, v32, v33
    ds_read_b128 v[200:203], v215 offset:24320
    v_exp_f32 v35, v35
    v_exp_f32 v36, v36
    v_cvt_pk_bf16_f32 v65, v34, v35
    v_exp_f32 v37, v37
    v_exp_f32 v38, v38
    v_mfma_f32_32x32x16_bf16 v[48:63], v[24:27], v[16:19], 0
    v_cvt_pk_bf16_f32 v66, v36, v37
    v_exp_f32 v39, v39
    v_exp_f32 v40, v40
    v_cvt_pk_bf16_f32 v67, v38, v39
    v_exp_f32 v41, v41
    v_mfma_f32_32x32x8_bf16 v[48:63], v[22:23], v[20:21], v[48:63]
    v_exp_f32 v42, v42
    v_cvt_pk_bf16_f32 v68, v40, v41
    v_exp_f32 v43, v43
    v_exp_f32 v44, v44
    ds_read_b128 v[24:27], v213 offset:28672
    v_cvt_pk_bf16_f32 v69, v42, v43
    s_waitcnt lgkmcnt(2)
    v_mfma_f32_32x32x16_bf16 v[80:95], v[28:31], v[64:67], v[80:95]
    ds_read_b64 v[22:23], v214 offset:31232
    s_add_u32 m0, s15, 139264
    s_mov_b32 s16, 129024
    s_mov_b64 exec, s[10:11]
    buffer_load_dwordx4 v206, s[64:67], s16 offen sc1 lds
    s_mov_b64 exec, -1
    v_exp_f32 v45, v45
    v_exp_f32 v46, v46
    v_cvt_pk_bf16_f32 v70, v44, v45
    v_exp_f32 v47, v47
    v_exp_f32 v48, v48
    v_cvt_pk_bf16_f32 v71, v46, v47
    v_exp_f32 v49, v49
    v_exp_f32 v50, v50
    s_waitcnt lgkmcnt(2)
    v_mfma_f32_32x32x16_bf16 v[80:95], v[200:203], v[68:71], v[80:95]
    v_cvt_pk_bf16_f32 v72, v48, v49
    v_exp_f32 v51, v51
    v_exp_f32 v52, v52
    v_cvt_pk_bf16_f32 v73, v50, v51
    v_exp_f32 v53, v53
    v_exp_f32 v54, v54
    s_waitcnt lgkmcnt(1)
    v_mfma_f32_32x32x16_bf16 v[32:47], v[24:27], v[8:11], 0
    v_cvt_pk_bf16_f32 v74, v52, v53
    v_exp_f32 v55, v55
    v_exp_f32 v56, v56
    v_cvt_pk_bf16_f32 v75, v54, v55
    v_exp_f32 v57, v57
    s_waitcnt lgkmcnt(0)
    v_mfma_f32_32x32x8_bf16 v[32:47], v[22:23], v[12:13], v[32:47]
    v_exp_f32 v58, v58
    v_cvt_pk_bf16_f32 v76, v56, v57
    v_exp_f32 v59, v59
    v_exp_f32 v60, v60
    v_cvt_pk_bf16_f32 v77, v58, v59
    v_mfma_f32_32x32x16_bf16 v[96:111], v[28:31], v[72:75], v[96:111]
    v_exp_f32 v61, v61
    ds_read_b128 v[28:31], v215 offset:29696
    v_exp_f32 v62, v62
    v_cvt_pk_bf16_f32 v78, v60, v61
    v_exp_f32 v63, v63
    s_nop 0
    v_exp_f32 v32, v32
    v_cvt_pk_bf16_f32 v79, v62, v63
    v_exp_f32 v33, v33
    v_exp_f32 v34, v34
    v_mfma_f32_32x32x16_bf16 v[96:111], v[200:203], v[76:79], v[96:111]
    v_cvt_pk_bf16_f32 v64, v32, v33
    ds_read_b128 v[200:203], v215 offset:30464
    v_exp_f32 v35, v35
    v_exp_f32 v36, v36
    v_cvt_pk_bf16_f32 v65, v34, v35
    v_exp_f32 v37, v37
    v_exp_f32 v38, v38
    v_mfma_f32_32x32x16_bf16 v[48:63], v[24:27], v[16:19], 0
    v_cvt_pk_bf16_f32 v66, v36, v37
    v_exp_f32 v39, v39
    v_exp_f32 v40, v40
    v_cvt_pk_bf16_f32 v67, v38, v39
    v_exp_f32 v41, v41
    v_mfma_f32_32x32x8_bf16 v[48:63], v[22:23], v[20:21], v[48:63]
    v_exp_f32 v42, v42
    v_cvt_pk_bf16_f32 v68, v40, v41
    s_waitcnt vmcnt(1) lgkmcnt(0)
    s_barrier
    v_exp_f32 v43, v43
    v_exp_f32 v44, v44
    ds_read_b128 v[24:27], v213 offset:34816
    v_cvt_pk_bf16_f32 v69, v42, v43
    v_mfma_f32_32x32x16_bf16 v[80:95], v[28:31], v[64:67], v[80:95]
    ds_read_b64 v[22:23], v214 offset:37376
    s_add_u32 m0, s15, 145408
    s_mov_b32 s16, 135168
    s_mov_b64 exec, s[10:11]
    buffer_load_dwordx4 v206, s[64:67], s16 offen sc1 lds
    s_mov_b64 exec, -1
    v_exp_f32 v45, v45
    v_exp_f32 v46, v46
    v_cvt_pk_bf16_f32 v70, v44, v45
    v_exp_f32 v47, v47
    v_exp_f32 v48, v48
    v_cvt_pk_bf16_f32 v71, v46, v47
    v_exp_f32 v49, v49
    v_exp_f32 v50, v50
    v_mfma_f32_32x32x16_bf16 v[80:95], v[200:203], v[68:71], v[80:95]
    v_cvt_pk_bf16_f32 v72, v48, v49
    v_exp_f32 v51, v51
    v_exp_f32 v52, v52
    v_cvt_pk_bf16_f32 v73, v50, v51
    v_exp_f32 v53, v53
    v_exp_f32 v54, v54
    s_waitcnt lgkmcnt(1)
    v_mfma_f32_32x32x16_bf16 v[32:47], v[24:27], v[8:11], 0
    v_cvt_pk_bf16_f32 v74, v52, v53
    v_exp_f32 v55, v55
    v_exp_f32 v56, v56
    v_cvt_pk_bf16_f32 v75, v54, v55
    v_exp_f32 v57, v57
    s_waitcnt lgkmcnt(0)
    v_mfma_f32_32x32x8_bf16 v[32:47], v[22:23], v[12:13], v[32:47]
    v_exp_f32 v58, v58
    v_cvt_pk_bf16_f32 v76, v56, v57
    v_exp_f32 v59, v59
    v_exp_f32 v60, v60
    v_cvt_pk_bf16_f32 v77, v58, v59
    v_mfma_f32_32x32x16_bf16 v[96:111], v[28:31], v[72:75], v[96:111]
    v_exp_f32 v61, v61
    ds_read_b128 v[28:31], v215 offset:35840
    v_exp_f32 v62, v62
    v_cvt_pk_bf16_f32 v78, v60, v61
    v_exp_f32 v63, v63
    s_nop 0
    v_exp_f32 v32, v32
    v_cvt_pk_bf16_f32 v79, v62, v63
    v_exp_f32 v33, v33
    v_exp_f32 v34, v34
    v_mfma_f32_32x32x16_bf16 v[96:111], v[200:203], v[76:79], v[96:111]
    v_cvt_pk_bf16_f32 v64, v32, v33
    ds_read_b128 v[200:203], v215 offset:36608
    v_exp_f32 v35, v35
    v_exp_f32 v36, v36
    v_cvt_pk_bf16_f32 v65, v34, v35
    v_exp_f32 v37, v37
    v_exp_f32 v38, v38
    v_mfma_f32_32x32x16_bf16 v[48:63], v[24:27], v[16:19], 0
    v_cvt_pk_bf16_f32 v66, v36, v37
    v_exp_f32 v39, v39
    v_exp_f32 v40, v40
    v_cvt_pk_bf16_f32 v67, v38, v39
    v_exp_f32 v41, v41
    v_mfma_f32_32x32x8_bf16 v[48:63], v[22:23], v[20:21], v[48:63]
    v_exp_f32 v42, v42
    v_cvt_pk_bf16_f32 v68, v40, v41
    v_exp_f32 v43, v43
    v_exp_f32 v44, v44
    ds_read_b128 v[24:27], v213 offset:10240
    v_cvt_pk_bf16_f32 v69, v42, v43
    s_waitcnt lgkmcnt(2)
    v_mfma_f32_32x32x16_bf16 v[80:95], v[28:31], v[64:67], v[80:95]
    ds_read_b64 v[22:23], v214 offset:12800
    s_add_u32 m0, s15, 151552
    s_mov_b32 s16, 141312
    s_mov_b64 exec, s[10:11]
    buffer_load_dwordx4 v206, s[64:67], s16 offen sc1 lds
    s_mov_b64 exec, -1
    v_exp_f32 v45, v45
    v_exp_f32 v46, v46
    v_cvt_pk_bf16_f32 v70, v44, v45
    v_exp_f32 v47, v47
    v_exp_f32 v48, v48
    v_cvt_pk_bf16_f32 v71, v46, v47
    v_exp_f32 v49, v49
    v_exp_f32 v50, v50
    s_waitcnt lgkmcnt(2)
    v_mfma_f32_32x32x16_bf16 v[80:95], v[200:203], v[68:71], v[80:95]
    v_cvt_pk_bf16_f32 v72, v48, v49
    v_exp_f32 v51, v51
    v_exp_f32 v52, v52
    v_cvt_pk_bf16_f32 v73, v50, v51
    v_exp_f32 v53, v53
    v_exp_f32 v54, v54
    s_waitcnt lgkmcnt(1)
    v_mfma_f32_32x32x16_bf16 v[32:47], v[24:27], v[8:11], 0
    v_cvt_pk_bf16_f32 v74, v52, v53
    v_exp_f32 v55, v55
    v_exp_f32 v56, v56
    v_cvt_pk_bf16_f32 v75, v54, v55
    v_exp_f32 v57, v57
    s_waitcnt lgkmcnt(0)
    v_mfma_f32_32x32x8_bf16 v[32:47], v[22:23], v[12:13], v[32:47]
    v_exp_f32 v58, v58
    v_cvt_pk_bf16_f32 v76, v56, v57
    v_exp_f32 v59, v59
    v_exp_f32 v60, v60
    v_cvt_pk_bf16_f32 v77, v58, v59
    v_mfma_f32_32x32x16_bf16 v[96:111], v[28:31], v[72:75], v[96:111]
    v_exp_f32 v61, v61
    ds_read_b128 v[28:31], v215 offset:11264
    v_exp_f32 v62, v62
    v_cvt_pk_bf16_f32 v78, v60, v61
    v_exp_f32 v63, v63
    s_nop 0
    v_exp_f32 v32, v32
    v_cvt_pk_bf16_f32 v79, v62, v63
    v_exp_f32 v33, v33
    v_exp_f32 v34, v34
    v_mfma_f32_32x32x16_bf16 v[96:111], v[200:203], v[76:79], v[96:111]
    v_cvt_pk_bf16_f32 v64, v32, v33
    ds_read_b128 v[200:203], v215 offset:12032
    v_exp_f32 v35, v35
    v_exp_f32 v36, v36
    v_cvt_pk_bf16_f32 v65, v34, v35
    v_exp_f32 v37, v37
    v_exp_f32 v38, v38
    v_mfma_f32_32x32x16_bf16 v[48:63], v[24:27], v[16:19], 0
    v_cvt_pk_bf16_f32 v66, v36, v37
    v_exp_f32 v39, v39
    v_exp_f32 v40, v40
    v_cvt_pk_bf16_f32 v67, v38, v39
    v_exp_f32 v41, v41
    v_mfma_f32_32x32x8_bf16 v[48:63], v[22:23], v[20:21], v[48:63]
    v_exp_f32 v42, v42
    v_cvt_pk_bf16_f32 v68, v40, v41
    s_waitcnt vmcnt(1) lgkmcnt(0)
    s_barrier
    s_cmp_lg_u32 s92, 7
    s_cbranch_scc1 sza2
    s_and_b32 s3, s2, 15
    s_lshl_b32 s3, s3, 8
    s_add_u32 s3, s3, 299008
    v_mov_b32 v232, s3
    v_mov_b32 v233, 1
    s_mov_b64 exec, 1
    buffer_atomic_add v233, v232, s[64:67], 0 offen sc1
    s_mov_b64 exec, -1
sza2:
    s_setprio 3
    v_exp_f32 v43, v43
    v_exp_f32 v44, v44
    ds_read_b128 v[24:27], v213 offset:16384
    v_cvt_pk_bf16_f32 v69, v42, v43
    v_mfma_f32_32x32x16_bf16 v[80:95], v[28:31], v[64:67], v[80:95]
    ds_read_b64 v[22:23], v214 offset:18944
    s_add_u32 m0, s15, 157696
    s_mov_b32 s16, 147456
    s_mov_b64 exec, s[10:11]
    buffer_load_dwordx4 v206, s[64:67], s16 offen sc1 lds
    s_mov_b64 exec, -1
    v_exp_f32 v45, v45
    v_exp_f32 v46, v46
    v_cvt_pk_bf16_f32 v70, v44, v45
    v_exp_f32 v47, v47
    v_exp_f32 v48, v48
    v_cvt_pk_bf16_f32 v71, v46, v47
    v_exp_f32 v49, v49
    s_add_u32 m0, s21, 0
    s_mov_b64 exec, s[12:13]
    buffer_load_dwordx4 v209, s[72:75], 0 offen lds
    s_mov_b64 exec, -1
    v_exp_f32 v50, v50
    v_mfma_f32_32x32x16_bf16 v[80:95], v[200:203], v[68:71], v[80:95]
    v_cvt_pk_bf16_f32 v72, v48, v49
    v_exp_f32 v51, v51
    v_exp_f32 v52, v52
    v_cvt_pk_bf16_f32 v73, v50, v51
    v_exp_f32 v53, v53
    s_add_u32 m0, s21, 6400
    s_mov_b32 s16, 51200
    s_mov_b64 exec, s[12:13]
    buffer_load_dwordx4 v209, s[72:75], s16 offen lds
    s_mov_b64 exec, -1
    v_exp_f32 v54, v54
    s_waitcnt lgkmcnt(1)
    v_mfma_f32_32x32x16_bf16 v[32:47], v[24:27], v[8:11], 0
    s_setprio 2
    v_cvt_pk_bf16_f32 v74, v52, v53
    v_exp_f32 v55, v55
    v_exp_f32 v56, v56
    v_cvt_pk_bf16_f32 v75, v54, v55
    v_exp_f32 v57, v57
    s_add_u32 m0, s21, 12800
    s_mov_b32 s16, 102400
    s_mov_b64 exec, s[12:13]
    buffer_load_dwordx4 v209, s[72:75], s16 offen lds
    s_mov_b64 exec, -1
    s_waitcnt lgkmcnt(0)
    v_mfma_f32_32x32x8_bf16 v[32:47], v[22:23], v[12:13], v[32:47]
    v_exp_f32 v58, v58
    v_cvt_pk_bf16_f32 v76, v56, v57
    v_exp_f32 v59, v59
    v_exp_f32 v60, v60
    v_cvt_pk_bf16_f32 v77, v58, v59
    v_mfma_f32_32x32x16_bf16 v[96:111], v[28:31], v[72:75], v[96:111]
    v_exp_f32 v61, v61
    ds_read_b128 v[28:31], v215 offset:17408
    v_exp_f32 v62, v62
    v_cvt_pk_bf16_f32 v78, v60, v61
    v_exp_f32 v63, v63
    s_waitcnt lgkmcnt(0)
    s_nop 5
l_j:
    v_exp_f32 v32, v32
    v_cvt_pk_bf16_f32 v79, v62, v63
    v_exp_f32 v33, v33
    v_exp_f32 v34, v34
    s_setprio 1
    v_mfma_f32_32x32x16_bf16 v[96:111], v[200:203], v[76:79], v[96:111]
    v_cvt_pk_bf16_f32 v64, v32, v33
    ds_read_b128 v[200:203], v215 offset:18176
    v_exp_f32 v35, v35
    v_exp_f32 v36, v36
    v_cvt_pk_bf16_f32 v65, v34, v35
    v_exp_f32 v37, v37
    v_exp_f32 v38, v38
    v_mfma_f32_32x32x16_bf16 v[48:63], v[24:27], v[16:19], 0
    v_cvt_pk_bf16_f32 v66, v36, v37
    v_exp_f32 v39, v39
    v_exp_f32 v40, v40
    v_cvt_pk_bf16_f32 v67, v38, v39
    s_setprio 0
    v_exp_f32 v41, v41
    v_mfma_f32_32x32x8_bf16 v[48:63], v[22:23], v[20:21], v[48:63]
    v_exp_f32 v42, v42
    v_cvt_pk_bf16_f32 v68, v40, v41
    s_setprio 3
    v_exp_f32 v43, v43
    v_exp_f32 v44, v44
    ds_read_b128 v[24:27], v213 offset:22528
    v_cvt_pk_bf16_f32 v69, v42, v43
    v_mfma_f32_32x32x16_bf16 v[80:95], v[28:31], v[64:67], v[80:95]
    ds_read_b64 v[22:23], v214 offset:25088
    s_add_u32 m0, s15, 133120
    s_mov_b32 s16, 153600
    s_mov_b64 exec, s[10:11]
    buffer_load_dwordx4 v206, s[64:67], s16 offen sc1 lds
    s_mov_b64 exec, -1
    v_exp_f32 v45, v45
    v_exp_f32 v46, v46
    v_cvt_pk_bf16_f32 v70, v44, v45
    v_exp_f32 v47, v47
    v_exp_f32 v48, v48
    v_cvt_pk_bf16_f32 v71, v46, v47
    v_exp_f32 v49, v49
    s_add_u32 m0, s21, 19200
    s_mov_b32 s16, 153600
    s_mov_b64 exec, s[12:13]
    buffer_load_dwordx4 v209, s[72:75], s16 offen lds
    s_mov_b64 exec, -1
    v_exp_f32 v50, v50
    s_waitcnt lgkmcnt(2)
    v_mfma_f32_32x32x16_bf16 v[80:95], v[200:203], v[68:71], v[80:95]
    v_cvt_pk_bf16_f32 v72, v48, v49
    v_exp_f32 v51, v51
    v_exp_f32 v52, v52
    v_cvt_pk_bf16_f32 v73, v50, v51
    v_exp_f32 v53, v53
    s_add_u32 m0, s21, 25600
    s_mov_b32 s16, 204800
    s_mov_b64 exec, s[12:13]
    buffer_load_dwordx4 v209, s[72:75], s16 offen lds
    s_mov_b64 exec, -1
    v_exp_f32 v54, v54
    s_waitcnt lgkmcnt(1)
    v_mfma_f32_32x32x16_bf16 v[32:47], v[24:27], v[8:11], 0
    s_setprio 2
    v_cvt_pk_bf16_f32 v74, v52, v53
    v_exp_f32 v55, v55
    v_exp_f32 v56, v56
    v_cvt_pk_bf16_f32 v75, v54, v55
    v_exp_f32 v57, v57
    s_add_u32 m0, s21, 32000
    s_mov_b32 s16, 256000
    s_mov_b64 exec, s[12:13]
    buffer_load_dwordx4 v209, s[72:75], s16 offen lds
    s_mov_b64 exec, -1
    s_waitcnt lgkmcnt(0)
    v_mfma_f32_32x32x8_bf16 v[32:47], v[22:23], v[12:13], v[32:47]
    v_exp_f32 v58, v58
    v_cvt_pk_bf16_f32 v76, v56, v57
    v_exp_f32 v59, v59
    v_exp_f32 v60, v60
    v_cvt_pk_bf16_f32 v77, v58, v59
    v_mfma_f32_32x32x16_bf16 v[96:111], v[28:31], v[72:75], v[96:111]
    v_exp_f32 v61, v61
    ds_read_b128 v[28:31], v215 offset:23552
    v_exp_f32 v62, v62
    v_cvt_pk_bf16_f32 v78, v60, v61
    v_exp_f32 v63, v63
    s_nop 0
    v_exp_f32 v32, v32
    v_cvt_pk_bf16_f32 v79, v62, v63
    v_exp_f32 v33, v33
    v_exp_f32 v34, v34
    s_setprio 1
    v_mfma_f32_32x32x16_bf16 v[96:111], v[200:203], v[76:79], v[96:111]
    v_cvt_pk_bf16_f32 v64, v32, v33
    ds_read_b128 v[200:203], v215 offset:24320
    v_exp_f32 v35, v35
    v_exp_f32 v36, v36
    v_cvt_pk_bf16_f32 v65, v34, v35
    v_exp_f32 v37, v37
    v_exp_f32 v38, v38
    v_mfma_f32_32x32x16_bf16 v[48:63], v[24:27], v[16:19], 0
    v_cvt_pk_bf16_f32 v66, v36, v37
    v_exp_f32 v39, v39
    v_exp_f32 v40, v40
    v_cvt_pk_bf16_f32 v67, v38, v39
    s_setprio 0
    v_exp_f32 v41, v41
    v_mfma_f32_32x32x8_bf16 v[48:63], v[22:23], v[20:21], v[48:63]
    v_exp_f32 v42, v42
    v_cvt_pk_bf16_f32 v68, v40, v41
    s_waitcnt vmcnt(7) lgkmcnt(0)
    s_barrier
    s_setprio 3
    v_exp_f32 v43, v43
    v_exp_f32 v44, v44
    ds_read_b128 v[24:27], v213 offset:28672
    v_cvt_pk_bf16_f32 v69, v42, v43
    v_mfma_f32_32x32x16_bf16 v[80:95], v[28:31], v[64:67], v[80:95]
    ds_read_b64 v[22:23], v214 offset:31232
    s_add_u32 m0, s15, 139264
    s_mov_b32 s16, 159744
    s_mov_b64 exec, s[10:11]
    buffer_load_dwordx4 v206, s[64:67], s16 offen sc1 lds
    s_mov_b64 exec, -1
    v_exp_f32 v45, v45
    v_exp_f32 v46, v46
    v_cvt_pk_bf16_f32 v70, v44, v45
    v_exp_f32 v47, v47
    v_exp_f32 v48, v48
    v_cvt_pk_bf16_f32 v71, v46, v47
    v_mov_b32 v233, 0
    ds_write2_b32 v250, v233, v233 offset0:0 offset1:4
    v_exp_f32 v49, v49
    v_exp_f32 v50, v50
    v_mfma_f32_32x32x16_bf16 v[80:95], v[200:203], v[68:71], v[80:95]
    v_cvt_pk_bf16_f32 v72, v48, v49
    v_exp_f32 v51, v51
    v_exp_f32 v52, v52
    s_add_u32 m0, s21, 38400
    s_mov_b32 s16, 307200
    s_mov_b64 exec, s[12:13]
    buffer_load_dwordx4 v209, s[72:75], s16 offen lds
    s_mov_b64 exec, -1
    v_cvt_pk_bf16_f32 v73, v50, v51
    v_exp_f32 v53, v53
    v_exp_f32 v54, v54
    s_waitcnt lgkmcnt(2)
    v_mfma_f32_32x32x16_bf16 v[32:47], v[24:27], v[8:11], 0
    s_setprio 2
    v_cvt_pk_bf16_f32 v74, v52, v53
    v_exp_f32 v55, v55
    s_add_u32 m0, s21, 44800
    s_mov_b32 s16, 358400
    s_mov_b64 exec, s[12:13]
    buffer_load_dwordx4 v209, s[72:75], s16 offen lds
    s_mov_b64 exec, -1
    v_exp_f32 v56, v56
    v_cvt_pk_bf16_f32 v75, v54, v55
    v_exp_f32 v57, v57
    s_waitcnt lgkmcnt(1)
    v_mfma_f32_32x32x8_bf16 v[32:47], v[22:23], v[12:13], v[32:47]
    v_exp_f32 v58, v58
    v_cvt_pk_bf16_f32 v76, v56, v57
    s_add_u32 m0, s21, 51200
    s_mov_b32 s16, 409600
    s_mov_b64 exec, s[12:13]
    buffer_load_dwordx4 v209, s[72:75], s16 offen lds
    s_mov_b64 exec, -1
    v_exp_f32 v59, v59
    v_exp_f32 v60, v60
    v_cvt_pk_bf16_f32 v77, v58, v59
    v_mfma_f32_32x32x16_bf16 v[96:111], v[28:31], v[72:75], v[96:111]
    v_exp_f32 v61, v61
    ds_read_b128 v[28:31], v215 offset:29696
    v_exp_f32 v62, v62
    v_cvt_pk_bf16_f32 v78, v60, v61
    v_exp_f32 v63, v63
    v_exp_f32 v32, v32
    v_cvt_pk_bf16_f32 v79, v62, v63
    v_exp_f32 v33, v33
    v_exp_f32 v34, v34
    s_setprio 1
    v_mfma_f32_32x32x16_bf16 v[96:111], v[200:203], v[76:79], v[96:111]
    v_cvt_pk_bf16_f32 v64, v32, v33
    ds_read_b128 v[200:203], v215 offset:30464
    v_exp_f32 v35, v35
    v_exp_f32 v36, v36
    v_cvt_pk_bf16_f32 v65, v34, v35
    v_exp_f32 v37, v37
    v_exp_f32 v38, v38
    v_mfma_f32_32x32x16_bf16 v[48:63], v[24:27], v[16:19], 0
    v_cvt_pk_bf16_f32 v66, v36, v37
    v_exp_f32 v39, v39
    v_exp_f32 v40, v40
    v_cvt_pk_bf16_f32 v67, v38, v39
    s_setprio 0
    v_exp_f32 v41, v41
    v_mfma_f32_32x32x8_bf16 v[48:63], v[22:23], v[20:21], v[48:63]
    v_exp_f32 v42, v42
    v_cvt_pk_bf16_f32 v68, v40, v41
    v_add_u32 v226, 4096, v226
    s_cmp_lg_u32 s92, 7
    s_cbranch_scc1 szl
    buffer_load_dword v227, v226, s[64:67], 0 offen sc1
szl:
    s_setprio 3
    v_exp_f32 v43, v43
    v_exp_f32 v44, v44
    ds_read_b128 v[24:27], v213 offset:34816
    v_cvt_pk_bf16_f32 v69, v42, v43
    s_waitcnt lgkmcnt(2)
    v_mfma_f32_32x32x16_bf16 v[80:95], v[28:31], v[64:67], v[80:95]
    ds_read_b64 v[22:23], v214 offset:37376
    s_add_u32 m0, s15, 145408
    s_mov_b32 s16, 165888
    s_mov_b64 exec, s[10:11]
    buffer_load_dwordx4 v206, s[64:67], s16 offen sc1 lds
    s_mov_b64 exec, -1
    v_exp_f32 v45, v45
    v_exp_f32 v46, v46
    v_cvt_pk_bf16_f32 v70, v44, v45
    v_exp_f32 v47, v47
    v_exp_f32 v48, v48
    v_cvt_pk_bf16_f32 v71, v46, v47
    s_lshl_b32 s3, s92, 2
    s_add_u32 s3, s3, 132224
    v_mov_b32 v239, s3
    v_xor_b32 v251, 16, v239
    ds_write_b32 v239, v233
    v_exp_f32 v49, v49
    v_exp_f32 v50, v50
    s_waitcnt lgkmcnt(3)
    v_mfma_f32_32x32x16_bf16 v[80:95], v[200:203], v[68:71], v[80:95]
    v_cvt_pk_bf16_f32 v72, v48, v49
    v_exp_f32 v51, v51
    v_exp_f32 v52, v52
    s_add_u32 m0, s21, 57600
    s_mov_b32 s16, 460800
    s_mov_b64 exec, s[12:13]
    buffer_load_dwordx4 v209, s[72:75], s16 offen lds
    s_mov_b64 exec, -1
    v_cvt_pk_bf16_f32 v73, v50, v51
    v_exp_f32 v53, v53
    v_exp_f32 v54, v54
    s_waitcnt lgkmcnt(2)
    v_mfma_f32_32x32x16_bf16 v[32:47], v[24:27], v[8:11], 0
    s_setprio 2
    v_cvt_pk_bf16_f32 v74, v52, v53
    v_exp_f32 v55, v55
    s_add_u32 m0, s21, 64000
    s_mov_b32 s16, 512000
    s_mov_b64 exec, s[12:13]
    buffer_load_dwordx4 v209, s[72:75], s16 offen lds
    s_mov_b64 exec, -1
    v_exp_f32 v56, v56
    v_cvt_pk_bf16_f32 v75, v54, v55
    v_exp_f32 v57, v57
    s_waitcnt lgkmcnt(1)
    v_mfma_f32_32x32x8_bf16 v[32:47], v[22:23], v[12:13], v[32:47]
    v_exp_f32 v58, v58
    v_cvt_pk_bf16_f32 v76, v56, v57
    s_add_u32 m0, s21, 70400
    s_mov_b32 s16, 563200
    s_mov_b64 exec, s[12:13]
    buffer_load_dwordx4 v209, s[72:75], s16 offen lds
    s_mov_b64 exec, -1
    v_exp_f32 v59, v59
    v_exp_f32 v60, v60
    v_cvt_pk_bf16_f32 v77, v58, v59
    v_mfma_f32_32x32x16_bf16 v[96:111], v[28:31], v[72:75], v[96:111]
    v_exp_f32 v61, v61
    ds_read_b128 v[28:31], v215 offset:35840
    v_exp_f32 v62, v62
    v_cvt_pk_bf16_f32 v78, v60, v61
    v_exp_f32 v63, v63
    v_exp_f32 v32, v32
    v_cvt_pk_bf16_f32 v79, v62, v63
    v_exp_f32 v33, v33
    v_exp_f32 v34, v34
    s_setprio 1
    v_mfma_f32_32x32x16_bf16 v[96:111], v[200:203], v[76:79], v[96:111]
    v_cvt_pk_bf16_f32 v64, v32, v33
    ds_read_b128 v[200:203], v215 offset:36608
    v_exp_f32 v35, v35
    v_exp_f32 v36, v36
    v_cvt_pk_bf16_f32 v65, v34, v35
    v_exp_f32 v37, v37
    v_exp_f32 v38, v38
    v_mfma_f32_32x32x16_bf16 v[48:63], v[24:27], v[16:19], 0
    v_cvt_pk_bf16_f32 v66, v36, v37
    v_exp_f32 v39, v39
    v_exp_f32 v40, v40
    v_cvt_pk_bf16_f32 v67, v38, v39
    s_setprio 0
    v_exp_f32 v41, v41
    v_mfma_f32_32x32x8_bf16 v[48:63], v[22:23], v[20:21], v[48:63]
    v_exp_f32 v42, v42
    v_cvt_pk_bf16_f32 v68, v40, v41
    s_cmp_lg_u32 s92, 7
    s_cbranch_scc1 sz_skip
    s_waitcnt vmcnt(4)
    v_cmp_gt_u32 vcc, 16, v227
    s_nop 0
    s_cbranch_vccz sz_out
    s_cmp_lg_u32 s92, 7
    s_cbranch_scc1 sz_skip
    s_mov_b32 s17, 0
sz_l:
    buffer_load_dword v227, v226, s[64:67], 0 offen sc1
    s_add_u32 s17, s17, 1
    s_cmp_gt_u32 s17, 1048576
    s_waitcnt vmcnt(0)
    v_cmp_gt_u32 vcc, 16, v227
    s_cbranch_scc1 sz_out
    s_cbranch_vccnz sz_l
sz_out:
sz_skip:
    s_waitcnt vmcnt(7) lgkmcnt(0)
    s_barrier
    s_setprio 3
    v_exp_f32 v43, v43
    v_exp_f32 v44, v44
    ds_read_b128 v[24:27], v213 offset:10240
    v_cvt_pk_bf16_f32 v69, v42, v43
    v_mfma_f32_32x32x16_bf16 v[80:95], v[28:31], v[64:67], v[80:95]
    ds_read_b64 v[22:23], v214 offset:12800
    s_add_u32 m0, s15, 151552
    s_mov_b32 s16, 172032
    s_mov_b64 exec, s[10:11]
    buffer_load_dwordx4 v206, s[64:67], s16 offen sc1 lds
    s_mov_b64 exec, -1
    v_exp_f32 v45, v45
    v_exp_f32 v46, v46
    v_cvt_pk_bf16_f32 v70, v44, v45
    v_exp_f32 v47, v47
    v_exp_f32 v48, v48
    s_add_u32 m0, s15, 122880
    s_mov_b32 s16, 190464
    s_mov_b64 exec, s[10:11]
    buffer_load_dwordx4 v206, s[64:67], s16 offen sc1 lds
    s_mov_b64 exec, -1
    v_cvt_pk_bf16_f32 v71, v46, v47
    v_exp_f32 v49, v49
    v_exp_f32 v50, v50
    v_mfma_f32_32x32x16_bf16 v[80:95], v[200:203], v[68:71], v[80:95]
    v_cvt_pk_bf16_f32 v72, v48, v49
    s_mul_i32 s3, s92, 3072
    s_add_u32 s3, s3, 139264
    v_add_u32 v244, s3, v5
    s_xor_b32 s3, s92, 4
    s_mul_i32 s3, s3, 3072
    s_add_u32 s3, s3, 139264
    v_add_u32 v245, s3, v5
    v_exp_f32 v51, v51
    v_exp_f32 v52, v52
    v_cvt_pk_bf16_f32 v73, v50, v51
    v_exp_f32 v53, v53
    v_exp_f32 v54, v54
    s_add_u32 m0, s21, 76800
    s_mov_b32 s16, 614400
    s_mov_b64 exec, s[12:13]
    buffer_load_dwordx4 v209, s[72:75], s16 offen lds
    s_mov_b64 exec, -1
    s_waitcnt lgkmcnt(1)
    v_mfma_f32_32x32x16_bf16 v[32:47], v[24:27], v[8:11], 0
    s_setprio 2
    v_cvt_pk_bf16_f32 v74, v52, v53
    v_exp_f32 v55, v55
    v_exp_f32 v56, v56
    v_cvt_pk_bf16_f32 v75, v54, v55
    s_add_u32 m0, s21, 83200
    s_mov_b32 s16, 665600
    s_mov_b64 exec, s[12:13]
    buffer_load_dwordx4 v209, s[72:75], s16 offen lds
    s_mov_b64 exec, -1
    v_exp_f32 v57, v57
    s_waitcnt lgkmcnt(0)
    v_mfma_f32_32x32x8_bf16 v[32:47], v[22:23], v[12:13], v[32:47]
    v_exp_f32 v58, v58
    v_cvt_pk_bf16_f32 v76, v56, v57
    v_exp_f32 v59, v59
    s_mov_b32 s28, -1
    s_mov_b32 s29, 0xfffffff
    s_add_u32 m0, s22, 102400
    s_mov_b64 exec, s[28:29]
    buffer_load_dwordx4 v210, s[64:67], 0 offen sc1 lds
    s_mov_b64 exec, -1
    v_exp_f32 v60, v60
    v_cvt_pk_bf16_f32 v77, v58, v59
    v_mfma_f32_32x32x16_bf16 v[96:111], v[28:31], v[72:75], v[96:111]
    v_exp_f32 v61, v61
    ds_read_b128 v[28:31], v215 offset:11264
    v_exp_f32 v62, v62
    v_cvt_pk_bf16_f32 v78, v60, v61
    v_exp_f32 v63, v63
    v_exp_f32 v32, v32
    v_cvt_pk_bf16_f32 v79, v62, v63
    v_exp_f32 v33, v33
    v_exp_f32 v34, v34
    s_setprio 1
    v_mfma_f32_32x32x16_bf16 v[96:111], v[200:203], v[76:79], v[96:111]
    v_cvt_pk_bf16_f32 v64, v32, v33
    ds_read_b128 v[200:203], v215 offset:12032
    v_exp_f32 v35, v35
    v_exp_f32 v36, v36
    v_cvt_pk_bf16_f32 v65, v34, v35
    v_exp_f32 v37, v37
    v_exp_f32 v38, v38
    v_mfma_f32_32x32x16_bf16 v[48:63], v[24:27], v[16:19], 0
    v_cvt_pk_bf16_f32 v66, v36, v37
    v_exp_f32 v39, v39
    v_exp_f32 v40, v40
    v_cvt_pk_bf16_f32 v67, v38, v39
    s_setprio 0
    v_exp_f32 v41, v41
    v_mfma_f32_32x32x8_bf16 v[48:63], v[22:23], v[20:21], v[48:63]
    v_exp_f32 v42, v42
    v_cvt_pk_bf16_f32 v68, v40, v41
    s_setprio 3
    v_exp_f32 v43, v43
    v_exp_f32 v44, v44
    ds_read_b128 v[24:27], v213 offset:16384
    v_cvt_pk_bf16_f32 v69, v42, v43
    s_waitcnt lgkmcnt(2)
    v_mfma_f32_32x32x16_bf16 v[80:95], v[28:31], v[64:67], v[80:95]
    ds_read_b64 v[22:23], v214 offset:18944
    s_add_u32 m0, s15, 157696
    s_mov_b32 s16, 178176
    s_mov_b64 exec, s[10:11]
    buffer_load_dwordx4 v206, s[64:67], s16 offen sc1 lds
    s_mov_b64 exec, -1
    v_exp_f32 v45, v45
    v_exp_f32 v46, v46
    v_cvt_pk_bf16_f32 v70, v44, v45
    v_exp_f32 v47, v47
    v_exp_f32 v48, v48
    v_cvt_pk_bf16_f32 v71, v46, v47
    v_exp_f32 v49, v49
    s_add_u32 m0, s21, 89600
    s_mov_b32 s16, 716800
    s_mov_b64 exec, s[12:13]
    buffer_load_dwordx4 v209, s[72:75], s16 offen lds
    s_mov_b64 exec, -1
    v_exp_f32 v50, v50
    s_waitcnt lgkmcnt(2)
    v_mfma_f32_32x32x16_bf16 v[80:95], v[200:203], v[68:71], v[80:95]
    v_cvt_pk_bf16_f32 v72, v48, v49
    v_exp_f32 v51, v51
    v_exp_f32 v52, v52
    v_cvt_pk_bf16_f32 v73, v50, v51
    v_exp_f32 v53, v53
    s_add_u32 m0, s21, 96000
    s_mov_b32 s16, 768000
    s_mov_b64 exec, s[12:13]
    buffer_load_dwordx4 v209, s[72:75], s16 offen lds
    s_mov_b64 exec, -1
    v_exp_f32 v54, v54
    s_waitcnt lgkmcnt(1)
    v_mfma_f32_32x32x16_bf16 v[32:47], v[24:27], v[8:11], 0
    s_setprio 2
    v_cvt_pk_bf16_f32 v74, v52, v53
    v_exp_f32 v55, v55
    v_exp_f32 v56, v56
    v_cvt_pk_bf16_f32 v75, v54, v55
    v_exp_f32 v57, v57
    s_add_u32 m0, s22, 103360
    s_mov_b32 s16, 4608
    s_mov_b64 exec, s[28:29]
    buffer_load_dwordx4 v210, s[64:67], s16 offen sc1 lds
    s_mov_b64 exec, -1
    s_waitcnt lgkmcnt(0)
    v_mfma_f32_32x32x8_bf16 v[32:47], v[22:23], v[12:13], v[32:47]
    v_exp_f32 v58, v58
    v_cvt_pk_bf16_f32 v76, v56, v57
    v_exp_f32 v59, v59
    v_exp_f32 v60, v60
    v_cvt_pk_bf16_f32 v77, v58, v59
    v_mfma_f32_32x32x16_bf16 v[96:111], v[28:31], v[72:75], v[96:111]
    v_exp_f32 v61, v61
    ds_read_b128 v[28:31], v215 offset:17408
    v_exp_f32 v62, v62
    v_cvt_pk_bf16_f32 v78, v60, v61
    v_exp_f32 v63, v63
    s_nop 0
    v_exp_f32 v32, v32
    v_cvt_pk_bf16_f32 v79, v62, v63
    v_exp_f32 v33, v33
    v_exp_f32 v34, v34
    s_setprio 1
    v_mfma_f32_32x32x16_bf16 v[96:111], v[200:203], v[76:79], v[96:111]
    v_cvt_pk_bf16_f32 v64, v32, v33
    ds_read_b128 v[200:203], v215 offset:18176
    v_exp_f32 v35, v35
    v_exp_f32 v36, v36
    v_cvt_pk_bf16_f32 v65, v34, v35
    v_exp_f32 v37, v37
    v_exp_f32 v38, v38
    v_mfma_f32_32x32x16_bf16 v[48:63], v[24:27], v[16:19], 0
    v_cvt_pk_bf16_f32 v66, v36, v37
    v_exp_f32 v39, v39
    v_exp_f32 v40, v40
    v_cvt_pk_bf16_f32 v67, v38, v39
    s_setprio 0
    v_exp_f32 v41, v41
    v_mfma_f32_32x32x8_bf16 v[48:63], v[22:23], v[20:21], v[48:63]
    v_exp_f32 v42, v42
    v_cvt_pk_bf16_f32 v68, v40, v41
    s_waitcnt vmcnt(12)
    s_barrier
    s_setprio 3
    v_exp_f32 v43, v43
    v_exp_f32 v44, v44
    ds_read_b128 v[24:27], v213 offset:22528
    v_cvt_pk_bf16_f32 v69, v42, v43
    s_waitcnt lgkmcnt(2)
    v_mfma_f32_32x32x16_bf16 v[80:95], v[28:31], v[64:67], v[80:95]
    ds_read_b64 v[22:23], v214 offset:25088
    s_add_u32 m0, s15, 133120
    s_mov_b32 s16, 184320
    s_mov_b64 exec, s[10:11]
    buffer_load_dwordx4 v206, s[64:67], s16 offen sc1 lds
    s_mov_b64 exec, -1
    v_exp_f32 v45, v45
    v_exp_f32 v46, v46
    v_cvt_pk_bf16_f32 v70, v44, v45
    v_exp_f32 v47, v47
    v_exp_f32 v48, v48
    v_cvt_pk_bf16_f32 v71, v46, v47
    v_exp_f32 v49, v49
    v_exp_f32 v50, v50
    s_waitcnt lgkmcnt(2)
    v_mfma_f32_32x32x16_bf16 v[80:95], v[200:203], v[68:71], v[80:95]
    v_cvt_pk_bf16_f32 v72, v48, v49
    v_exp_f32 v51, v51
    v_exp_f32 v52, v52
    v_cvt_pk_bf16_f32 v73, v50, v51
    v_exp_f32 v53, v53
    v_exp_f32 v54, v54
    s_add_u32 m0, s22, 104320
    s_mov_b32 s16, 9216
    s_mov_b64 exec, s[8:9]
    buffer_load_dwordx4 v210, s[64:67], s16 offen sc1 lds
    s_mov_b64 exec, -1
    s_waitcnt lgkmcnt(1)
    v_mfma_f32_32x32x16_bf16 v[32:47], v[24:27], v[8:11], 0
    s_setprio 2
    v_cvt_pk_bf16_f32 v74, v52, v53
    v_exp_f32 v55, v55
    v_exp_f32 v56, v56
    v_cvt_pk_bf16_f32 v75, v54, v55
    v_exp_f32 v57, v57
    s_waitcnt lgkmcnt(0)
    v_mfma_f32_32x32x8_bf16 v[32:47], v[22:23], v[12:13], v[32:47]
    v_exp_f32 v58, v58
    v_cvt_pk_bf16_f32 v76, v56, v57
    v_exp_f32 v59, v59
    v_exp_f32 v60, v60
    v_cvt_pk_bf16_f32 v77, v58, v59
    v_mfma_f32_32x32x16_bf16 v[96:111], v[28:31], v[72:75], v[96:111]
    v_exp_f32 v61, v61
    ds_read_b128 v[28:31], v215 offset:23552
    v_exp_f32 v62, v62
    v_cvt_pk_bf16_f32 v78, v60, v61
    v_exp_f32 v63, v63
    s_nop 0
    v_exp_f32 v32, v32
    v_cvt_pk_bf16_f32 v79, v62, v63
    v_exp_f32 v33, v33
    v_exp_f32 v34, v34
    s_setprio 1
    v_mfma_f32_32x32x16_bf16 v[96:111], v[200:203], v[76:79], v[96:111]
    v_cvt_pk_bf16_f32 v64, v32, v33
    ds_read_b128 v[200:203], v215 offset:24320
    v_exp_f32 v35, v35
    v_exp_f32 v36, v36
    v_cvt_pk_bf16_f32 v65, v34, v35
    v_exp_f32 v37, v37
    v_exp_f32 v38, v38
    v_mfma_f32_32x32x16_bf16 v[48:63], v[24:27], v[16:19], 0
    v_cvt_pk_bf16_f32 v66, v36, v37
    v_exp_f32 v39, v39
    v_exp_f32 v40, v40
    v_cvt_pk_bf16_f32 v67, v38, v39
    s_setprio 0
    v_exp_f32 v41, v41
    v_mfma_f32_32x32x8_bf16 v[48:63], v[22:23], v[20:21], v[48:63]
    v_exp_f32 v42, v42
    v_cvt_pk_bf16_f32 v68, v40, v41
    s_waitcnt vmcnt(5)
    s_barrier
    s_setprio 3
    v_exp_f32 v43, v43
    v_exp_f32 v44, v44
    ds_read_b128 v[24:27], v213 offset:28672
    v_cvt_pk_bf16_f32 v69, v42, v43
    s_waitcnt lgkmcnt(2)
    v_mfma_f32_32x32x16_bf16 v[80:95], v[28:31], v[64:67], v[80:95]
    ds_read_b64 v[22:23], v214 offset:31232
    v_exp_f32 v45, v45
    v_exp_f32 v46, v46
    v_cvt_pk_bf16_f32 v70, v44, v45
    v_exp_f32 v47, v47
    ds_read_b128 v[144:147], v211 offset:34816
    v_exp_f32 v48, v48
    v_cvt_pk_bf16_f32 v71, v46, v47
    v_exp_f32 v49, v49
    v_exp_f32 v50, v50
    s_waitcnt lgkmcnt(3)
    v_mfma_f32_32x32x16_bf16 v[80:95], v[200:203], v[68:71], v[80:95]
    ds_read_b64 v[148:149], v212 offset:37376
    v_cvt_pk_bf16_f32 v72, v48, v49
    v_exp_f32 v51, v51
    v_exp_f32 v52, v52
    v_cvt_pk_bf16_f32 v73, v50, v51
    v_exp_f32 v53, v53
    ds_read_b128 v[160:163], v211 offset:37888
    v_exp_f32 v54, v54
    s_waitcnt lgkmcnt(4)
    v_mfma_f32_32x32x16_bf16 v[32:47], v[24:27], v[8:11], 0
    s_setprio 2
    v_cvt_pk_bf16_f32 v74, v52, v53
    v_exp_f32 v55, v55
    v_exp_f32 v56, v56
    ds_read_b64 v[164:165], v212 offset:40448
    v_cvt_pk_bf16_f32 v75, v54, v55
    v_exp_f32 v57, v57
    s_waitcnt lgkmcnt(4)
    v_mfma_f32_32x32x8_bf16 v[32:47], v[22:23], v[12:13], v[32:47]
    v_exp_f32 v58, v58
    v_cvt_pk_bf16_f32 v76, v56, v57
    ds_read_b128 v[152:155], v7 offset:35840
    v_exp_f32 v59, v59
    v_exp_f32 v60, v60
    v_cvt_pk_bf16_f32 v77, v58, v59
    v_mfma_f32_32x32x16_bf16 v[96:111], v[28:31], v[72:75], v[96:111]
    v_exp_f32 v61, v61
    ds_read_b128 v[28:31], v215 offset:29696
    ds_read_b128 v[156:159], v7 offset:36608
    v_exp_f32 v62, v62
    v_cvt_pk_bf16_f32 v78, v60, v61
    v_exp_f32 v63, v63
    v_exp_f32 v32, v32
    v_cvt_pk_bf16_f32 v79, v62, v63
    ds_read_b128 v[168:171], v7 offset:38912
    v_exp_f32 v33, v33
    v_exp_f32 v34, v34
    s_setprio 1
    v_mfma_f32_32x32x16_bf16 v[96:111], v[200:203], v[76:79], v[96:111]
    v_cvt_pk_bf16_f32 v64, v32, v33
    ds_read_b128 v[200:203], v215 offset:30464
    v_exp_f32 v35, v35
    ds_read_b128 v[172:175], v7 offset:39680
    v_exp_f32 v36, v36
    v_cvt_pk_bf16_f32 v65, v34, v35
    v_exp_f32 v37, v37
    v_exp_f32 v38, v38
    v_mfma_f32_32x32x16_bf16 v[48:63], v[24:27], v[16:19], 0
    v_cvt_pk_bf16_f32 v66, v36, v37
    v_exp_f32 v39, v39
    v_exp_f32 v40, v40
    v_cvt_pk_bf16_f32 v67, v38, v39
    s_setprio 0
    v_exp_f32 v41, v41
    v_mfma_f32_32x32x8_bf16 v[48:63], v[22:23], v[20:21], v[48:63]
    v_exp_f32 v42, v42
    v_cvt_pk_bf16_f32 v68, v40, v41
    s_waitcnt vmcnt(0) lgkmcnt(0)
    s_barrier
    s_setprio 1
    s_cmp_lg_u32 s96, 0
    s_cbranch_scc1 l_lead
    s_setprio 3
l_lead:
    v_exp_f32 v43, v43
    v_exp_f32 v44, v44
    v_cvt_pk_bf16_f32 v69, v42, v43
    v_mfma_f32_32x32x16_bf16 v[80:95], v[28:31], v[64:67], v[80:95]
    v_exp_f32 v45, v45
    v_exp_f32 v46, v46
    v_cvt_pk_bf16_f32 v70, v44, v45
    v_exp_f32 v47, v47
    v_exp_f32 v48, v48
    v_cvt_pk_bf16_f32 v71, v46, v47
    v_exp_f32 v49, v49
    v_exp_f32 v50, v50
    v_mfma_f32_32x32x16_bf16 v[80:95], v[200:203], v[68:71], v[80:95]
    v_cvt_pk_bf16_f32 v72, v48, v49
    v_exp_f32 v51, v51
    v_exp_f32 v52, v52
    v_cvt_pk_bf16_f32 v73, v50, v51
    v_exp_f32 v53, v53
    v_exp_f32 v54, v54
    v_mfma_f32_32x32x16_bf16 v[32:47], v[144:147], v[16:19], 0
    v_cvt_pk_bf16_f32 v74, v52, v53
    v_exp_f32 v55, v55
    v_exp_f32 v56, v56
    v_cvt_pk_bf16_f32 v75, v54, v55
    v_exp_f32 v57, v57
    ds_write_b128 v244, v[80:83] offset:0
    v_mfma_f32_32x32x8_bf16 v[32:47], v[148:149], v[20:21], v[32:47]
    v_exp_f32 v58, v58
    ds_write_b128 v244, v[84:87] offset:1024
    v_cvt_pk_bf16_f32 v76, v56, v57
    v_exp_f32 v59, v59
    ds_write_b128 v244, v[88:91] offset:2048
    v_exp_f32 v60, v60
    ds_write_b32 v239, v239
    v_cvt_pk_bf16_f32 v77, v58, v59
    v_mfma_f32_32x32x16_bf16 v[96:111], v[28:31], v[72:75], v[96:111]
    v_exp_f32 v61, v61
    v_exp_f32 v62, v62
    v_cvt_pk_bf16_f32 v78, v60, v61
    v_exp_f32 v63, v63
    v_exp_f32 v32, v32
    v_cvt_pk_bf16_f32 v79, v62, v63
    v_exp_f32 v33, v33
    v_exp_f32 v34, v34
    v_mfma_f32_32x32x16_bf16 v[96:111], v[200:203], v[76:79], v[96:111]
    v_cvt_pk_bf16_f32 v64, v32, v33
    v_exp_f32 v35, v35
    v_exp_f32 v36, v36
    v_cvt_pk_bf16_f32 v65, v34, v35
    v_exp_f32 v37, v37
    v_exp_f32 v38, v38
    v_mfma_f32_32x32x16_bf16 v[48:63], v[160:163], v[16:19], 0
    v_cvt_pk_bf16_f32 v66, v36, v37
    v_exp_f32 v39, v39
    v_exp_f32 v40, v40
    v_cvt_pk_bf16_f32 v67, v38, v39
    v_exp_f32 v41, v41
    v_mfma_f32_32x32x8_bf16 v[48:63], v[164:165], v[20:21], v[48:63]
    v_exp_f32 v42, v42
    v_cvt_pk_bf16_f32 v68, v40, v41
    v_exp_f32 v43, v43
    v_exp_f32 v44, v44
    ds_read_b128 v[24:27], v211 offset:10240
    v_cvt_pk_bf16_f32 v69, v42, v43
    v_mfma_f32_32x32x16_bf16 v[96:111], v[152:155], v[64:67], v[96:111]
    ds_read_b64 v[22:23], v212 offset:12800
    v_exp_f32 v45, v45
    v_exp_f32 v46, v46
    v_cvt_pk_bf16_f32 v70, v44, v45
    v_exp_f32 v47, v47
    v_exp_f32 v48, v48
    v_cvt_pk_bf16_f32 v71, v46, v47
    v_exp_f32 v49, v49
    v_exp_f32 v50, v50
    v_mfma_f32_32x32x16_bf16 v[96:111], v[156:159], v[68:71], v[96:111]
    v_cvt_pk_bf16_f32 v72, v48, v49
    v_exp_f32 v51, v51
    v_exp_f32 v52, v52
    v_cvt_pk_bf16_f32 v73, v50, v51
    v_exp_f32 v53, v53
    v_exp_f32 v54, v54
    s_waitcnt lgkmcnt(1)
    v_mfma_f32_32x32x16_bf16 v[32:47], v[24:27], v[16:19], 0
    s_lshl_b32 s3, s93, 8
    s_add_u32 s3, s3, 262144
    s_lshl_b32 s4, s34, 6
    s_add_u32 s4, s4, s3
    buffer_load_dword v246, v246, s[64:67], s4 offen sc1
    s_lshl_b32 s4, s96, 7
    s_add_u32 s4, s4, s3
    buffer_load_dword v247, v247, s[64:67], s4 offen sc1
    v_cvt_pk_bf16_f32 v74, v52, v53
    ds_read_b128 v[24:27], v211 offset:13312
    v_exp_f32 v55, v55
    v_exp_f32 v56, v56
    v_cvt_pk_bf16_f32 v75, v54, v55
    v_exp_f32 v57, v57
    s_waitcnt lgkmcnt(1)
    v_mfma_f32_32x32x8_bf16 v[32:47], v[22:23], v[20:21], v[32:47]
    v_exp_f32 v58, v58
    ds_read_b64 v[22:23], v212 offset:15872
    v_cvt_pk_bf16_f32 v76, v56, v57
    v_exp_f32 v59, v59
    v_exp_f32 v60, v60
    v_cvt_pk_bf16_f32 v77, v58, v59
    v_mfma_f32_32x32x16_bf16 v[96:111], v[168:171], v[72:75], v[96:111]
    v_exp_f32 v61, v61
    ds_read_b128 v[28:31], v7 offset:11264
    v_exp_f32 v62, v62
    v_cvt_pk_bf16_f32 v78, v60, v61
    v_exp_f32 v63, v63
    v_exp_f32 v32, v32
    v_cvt_pk_bf16_f32 v79, v62, v63
    v_exp_f32 v33, v33
    v_exp_f32 v34, v34
    v_mfma_f32_32x32x16_bf16 v[96:111], v[172:175], v[76:79], v[96:111]
    v_cvt_pk_bf16_f32 v64, v32, v33
    ds_read_b128 v[200:203], v7 offset:12032
    v_exp_f32 v35, v35
    v_exp_f32 v36, v36
    v_cvt_pk_bf16_f32 v65, v34, v35
    v_exp_f32 v37, v37
    v_exp_f32 v38, v38
    s_waitcnt lgkmcnt(3)
    v_mfma_f32_32x32x16_bf16 v[48:63], v[24:27], v[16:19], 0
    v_cvt_pk_bf16_f32 v66, v36, v37
    v_exp_f32 v39, v39
    v_exp_f32 v40, v40
    v_cvt_pk_bf16_f32 v67, v38, v39
    v_exp_f32 v41, v41
    s_waitcnt lgkmcnt(2)
    v_mfma_f32_32x32x8_bf16 v[48:63], v[22:23], v[20:21], v[48:63]
    v_exp_f32 v42, v42
    v_cvt_pk_bf16_f32 v68, v40, v41
    v_exp_f32 v43, v43
    v_exp_f32 v44, v44
    ds_read_b128 v[24:27], v211 offset:0
    v_cvt_pk_bf16_f32 v69, v42, v43
    s_waitcnt lgkmcnt(2)
    v_mfma_f32_32x32x16_bf16 v[96:111], v[28:31], v[64:67], v[96:111]
    ds_read_b64 v[22:23], v212 offset:2560
    v_exp_f32 v45, v45
    ds_read_b128 v[28:31], v7 offset:14336
    v_exp_f32 v46, v46
    v_cvt_pk_bf16_f32 v70, v44, v45
    v_exp_f32 v47, v47
    v_exp_f32 v48, v48
    v_cvt_pk_bf16_f32 v71, v46, v47
    v_exp_f32 v49, v49
    v_exp_f32 v50, v50
    s_waitcnt lgkmcnt(3)
    v_mfma_f32_32x32x16_bf16 v[96:111], v[200:203], v[68:71], v[96:111]
    v_cvt_pk_bf16_f32 v72, v48, v49
    ds_read_b128 v[200:203], v7 offset:15104
    v_exp_f32 v51, v51
    v_exp_f32 v52, v52
    v_cvt_pk_bf16_f32 v73, v50, v51
    v_exp_f32 v53, v53
    v_exp_f32 v54, v54
    s_waitcnt lgkmcnt(3)
    v_mfma_f32_32x32x16_bf16 v[32:47], v[24:27], v[16:19], 0
    v_cvt_pk_bf16_f32 v74, v52, v53
    ds_read_b128 v[24:27], v211 offset:3072
    v_exp_f32 v55, v55
    v_exp_f32 v56, v56
    v_cvt_pk_bf16_f32 v75, v54, v55
    v_exp_f32 v57, v57
    s_waitcnt lgkmcnt(3)
    v_mfma_f32_32x32x8_bf16 v[32:47], v[22:23], v[20:21], v[32:47]
    v_exp_f32 v58, v58
    ds_read_b64 v[22:23], v212 offset:5632
    v_cvt_pk_bf16_f32 v76, v56, v57
    v_exp_f32 v59, v59
    v_exp_f32 v60, v60
    v_cvt_pk_bf16_f32 v77, v58, v59
    s_waitcnt lgkmcnt(3)
    v_mfma_f32_32x32x16_bf16 v[96:111], v[28:31], v[72:75], v[96:111]
    v_exp_f32 v61, v61
    ds_read_b128 v[28:31], v7 offset:1024
    v_exp_f32 v62, v62
    v_cvt_pk_bf16_f32 v78, v60, v61
    v_exp_f32 v63, v63
    v_exp_f32 v32, v32
    v_cvt_pk_bf16_f32 v79, v62, v63
    v_exp_f32 v33, v33
    v_exp_f32 v34, v34
    s_waitcnt lgkmcnt(3)
    v_mfma_f32_32x32x16_bf16 v[96:111], v[200:203], v[76:79], v[96:111]
    v_cvt_pk_bf16_f32 v64, v32, v33
    ds_read_b128 v[200:203], v7 offset:1792
    v_exp_f32 v35, v35
    v_exp_f32 v36, v36
    v_cvt_pk_bf16_f32 v65, v34, v35
    v_exp_f32 v37, v37
    v_exp_f32 v38, v38
    s_waitcnt lgkmcnt(3)
    v_mfma_f32_32x32x16_bf16 v[48:63], v[24:27], v[16:19], 0
    v_cvt_pk_bf16_f32 v66, v36, v37
    v_exp_f32 v39, v39
    v_exp_f32 v40, v40
    v_cvt_pk_bf16_f32 v67, v38, v39
    v_exp_f32 v41, v41
    s_waitcnt lgkmcnt(2)
    v_mfma_f32_32x32x8_bf16 v[48:63], v[22:23], v[20:21], v[48:63]
    v_exp_f32 v42, v42
    v_cvt_pk_bf16_f32 v68, v40, v41
    v_exp_f32 v43, v43
    v_exp_f32 v44, v44
    v_cvt_pk_bf16_f32 v69, v42, v43
    s_waitcnt lgkmcnt(1)
    v_mfma_f32_32x32x16_bf16 v[96:111], v[28:31], v[64:67], v[96:111]
    v_exp_f32 v45, v45
    ds_read_b128 v[28:31], v7 offset:4096
    v_exp_f32 v46, v46
    v_cvt_pk_bf16_f32 v70, v44, v45
    v_exp_f32 v47, v47
    v_exp_f32 v48, v48
    v_cvt_pk_bf16_f32 v71, v46, v47
    v_exp_f32 v49, v49
    v_exp_f32 v50, v50
    s_waitcnt lgkmcnt(1)
    v_mfma_f32_32x32x16_bf16 v[96:111], v[200:203], v[68:71], v[96:111]
    v_cvt_pk_bf16_f32 v72, v48, v49
    ds_read_b128 v[200:203], v7 offset:4864
    v_exp_f32 v51, v51
    v_exp_f32 v52, v52
    v_cvt_pk_bf16_f32 v73, v50, v51
    v_exp_f32 v53, v53
    v_exp_f32 v54, v54
    v_cvt_pk_bf16_f32 v74, v52, v53
    v_exp_f32 v55, v55
    v_exp_f32 v56, v56
    v_cvt_pk_bf16_f32 v75, v54, v55
    v_exp_f32 v57, v57
    v_exp_f32 v58, v58
    v_cvt_pk_bf16_f32 v76, v56, v57
    ds_read_b32 v44, v251
    ds_read_b128 v[40:43], v245 offset:2048
    ds_read_b128 v[32:35], v245 offset:0
    ds_read_b128 v[36:39], v245 offset:1024
    v_exp_f32 v59, v59
    v_exp_f32 v60, v60
    v_cvt_pk_bf16_f32 v77, v58, v59
    s_waitcnt lgkmcnt(5)
    v_mfma_f32_32x32x16_bf16 v[96:111], v[28:31], v[72:75], v[96:111]
    v_exp_f32 v61, v61
    v_exp_f32 v62, v62
    v_cvt_pk_bf16_f32 v78, v60, v61
    v_exp_f32 v63, v63
    s_nop 0
    v_cvt_pk_bf16_f32 v79, v62, v63
    s_waitcnt lgkmcnt(4)
    s_nop 0
    v_mfma_f32_32x32x16_bf16 v[96:111], v[200:203], v[76:79], v[96:111]
    s_lshl_b32 s3, s93, 2
    s_add_u32 s3, s3, s34
    s_mul_i32 s3, s3, 20480
    s_add_u32 s3, s3, 4194304
    s_lshl_b32 s4, s35, 13
    s_add_u32 s24, s3, s4
    s_add_u32 s25, s24, 4096
    s_lshl_b32 s4, s35, 11
    s_add_u32 s3, s3, s4
    s_add_u32 s26, s3, 16384
    v_lshlrev_b32 v232, 3, v3
    v_lshl_add_u32 v232, v2, 9, v232
    v_and_b32 v233, 1, v4
    s_movk_i32 s3, 384
    v_mad_u32_u24 v248, v233, s3, v232
    v_lshl_add_u32 v249, v233, 7, v232
    s_mov_b32 s17, 0
    s_waitcnt lgkmcnt(3)
    v_cmp_eq_u32 vcc, 0, v44
    s_nop 0
    s_cbranch_vccz t_ok0
t_pl0:
    ds_read_b32 v44, v251
    s_add_u32 s17, s17, 1
    s_cmp_gt_u32 s17, 16777216
    s_waitcnt lgkmcnt(0)
    v_cmp_eq_u32 vcc, 0, v44
    s_cbranch_scc1 t_pm0
    s_cbranch_vccnz t_pl0
t_pm0:
    ds_read_b128 v[40:43], v245 offset:2048
    ds_read_b128 v[32:35], v245 offset:0
    ds_read_b128 v[36:39], v245 offset:1024
t_ok0:
    s_waitcnt lgkmcnt(2)
    v_add_f32 v242, v104, v40
    v_add_f32 v232, v104, v40
    v_pk_add_f32 v[104:105], v[104:105], v[40:41]
    v_pk_add_f32 v[106:107], v[106:107], v[42:43]
    v_permlane32_swap_b32 v232, v242
    s_waitcnt lgkmcnt(1)
    v_pk_add_f32 v[96:97], v[96:97], v[32:33]
    v_pk_add_f32 v[98:99], v[98:99], v[34:35]
    s_waitcnt lgkmcnt(0)
    v_pk_add_f32 v[100:101], v[100:101], v[36:37]
    v_pk_add_f32 v[102:103], v[102:103], v[38:39]
    s_mov_b32 s3, 0x1f800000
    v_cmp_nle_f32 vcc, s3, v242
    s_nop 0
    s_cbranch_vccnz t_fallback
t_st0:
    v_rcp_f32 v242, v242
    s_waitcnt vmcnt(0)
    v_mul_f32 v242, v242, v247
    v_pk_mul_f32 v[96:97], v[96:97], v[242:243] op_sel_hi:[1,0]
    v_pk_mul_f32 v[98:99], v[98:99], v[242:243] op_sel_hi:[1,0]
    v_pk_mul_f32 v[100:101], v[100:101], v[242:243] op_sel_hi:[1,0]
    v_pk_mul_f32 v[102:103], v[102:103], v[242:243] op_sel_hi:[1,0]
    v_cvt_pk_bf16_f32 v32, v96, v97
    v_cvt_pk_bf16_f32 v33, v98, v99
    v_cvt_pk_bf16_f32 v34, v100, v101
    v_cvt_pk_bf16_f32 v35, v102, v103
    v_pk_mul_f32 v[104:105], v[104:105], v[242:243] op_sel_hi:[1,0]
    v_min_u32 v32, -2, v32
    v_min_u32 v33, -2, v33
    v_min_u32 v34, -2, v34
    v_min_u32 v35, -2, v35
    v_pk_mul_f32 v[106:107], v[106:107], v[242:243] op_sel_hi:[1,0]
    buffer_store_dwordx4 v[32:35], v14, s[64:67], 0 offen sc1
    v_cvt_pk_bf16_f32 v36, v104, v105
    v_cvt_pk_bf16_f32 v37, v106, v107
    v_min_u32 v36, -2, v36
    v_min_u32 v37, -2, v37
    s_mov_b32 exec_hi, 0
    buffer_store_dwordx2 v[36:37], v15, s[64:67], 0 offen sc1
    s_mov_b32 exec_hi, -1
    s_cmp_eq_u32 s96, 0
    s_cbranch_scc1 t_ld
    s_barrier
    ds_read2st64_b32 v[144:145], v224 offset0:0 offset1:5
    ds_read2st64_b32 v[146:147], v224 offset0:10 offset1:15
    ds_read2st64_b32 v[48:49], v224 offset0:20 offset1:25
    ds_read2st64_b32 v[50:51], v224 offset0:30 offset1:35
    v_add_u32 v224, s27, v224
    ds_read2st64_b32 v[148:149], v224 offset0:0 offset1:5
    ds_read2st64_b32 v[150:151], v224 offset0:10 offset1:15
    ds_read2st64_b32 v[52:53], v224 offset0:20 offset1:25
    ds_read2st64_b32 v[54:55], v224 offset0:30 offset1:35
    v_add_u32 v224, s27, v224
    ds_read2st64_b32 v[152:153], v224 offset0:0 offset1:5
    ds_read2st64_b32 v[154:155], v224 offset0:10 offset1:15
    ds_read2st64_b32 v[56:57], v224 offset0:20 offset1:25
    ds_read2st64_b32 v[58:59], v224 offset0:30 offset1:35
    v_add_u32 v224, s27, v224
    ds_read2st64_b32 v[156:157], v224 offset0:0 offset1:5
    ds_read2st64_b32 v[158:159], v224 offset0:10 offset1:15
    ds_read2st64_b32 v[60:61], v224 offset0:20 offset1:25
    s_waitcnt lgkmcnt(8)
    ds_read2st64_b32 v[62:63], v224 offset0:30 offset1:35
    v_add_u32 v224, s27, v224
    ds_read2st64_b32 v[160:161], v224 offset0:0 offset1:5
    ds_read2st64_b32 v[162:163], v224 offset0:10 offset1:15
    ds_read2st64_b32 v[64:65], v224 offset0:20 offset1:25
    ds_read2st64_b32 v[66:67], v224 offset0:30 offset1:35
    v_mfma_f32_16x16x32_bf16 v[164:167], v[144:147], v[136:139], 0
    s_mul_i32 s3, s34, 3072
    s_add_u32 s3, s3, 139264
    s_cmp_eq_u32 s34, 3
    v_mfma_f32_16x16x32_bf16 v[164:167], v[48:51], v[140:143], v[164:167]
    s_cselect_b32 s3, 129024, s3
    v_add_u32 v240, s3, v5
    s_lshl_b32 s3, s34, 11
    v_mfma_f32_16x16x32_bf16 v[168:171], v[148:151], v[136:139], 0
    s_add_u32 s3, s3, 145408
    v_add_u32 v241, s3, v5
    v_sub_f32 v246, 1.0, v246
    s_waitcnt lgkmcnt(12)
    v_mfma_f32_16x16x32_bf16 v[168:171], v[52:55], v[140:143], v[168:171]
    v_cvt_pk_bf16_f32 v246, v246, v246
    v_lshlrev_b32 v246, 16, v246
    s_cmp_lt_u32 s94, 4
    s_waitcnt lgkmcnt(10)
    v_mfma_f32_16x16x32_bf16 v[172:175], v[152:155], v[136:139], 0
    s_cselect_b32 s3, s35, 0
    s_lshl_b32 s3, s3, 31
    v_xor_b32 v246, s3, v246
    s_waitcnt lgkmcnt(8)
    v_mfma_f32_16x16x32_bf16 v[172:175], v[56:59], v[140:143], v[172:175]
    s_and_b32 s3, s97, 1
    s_lshl_b32 s3, s3, 5
    s_add_u32 s3, s3, s96
    s_waitcnt lgkmcnt(6)
    v_mfma_f32_16x16x32_bf16 v[176:179], v[156:159], v[136:139], 0
    s_mul_i32 s3, s3, 40960
    s_add_u32 s3, s3, s95
    s_mul_i32 s4, s94, 160
    s_waitcnt lgkmcnt(4)
    v_mfma_f32_16x16x32_bf16 v[176:179], v[60:63], v[140:143], v[176:179]
    s_add_u32 s3, s3, s4
    v_mul_u32_u24 v237, 81920, v3
    v_add_u32 v237, s3, v237
    s_waitcnt lgkmcnt(2)
    v_mfma_f32_16x16x32_bf16 v[180:183], v[160:163], v[136:139], 0
    v_lshl_add_u32 v238, v2, 4, v237
    v_lshl_add_u32 v237, v4, 3, v237
    v_and_b32 v233, 16, v0
    s_waitcnt lgkmcnt(0)
    v_mfma_f32_16x16x32_bf16 v[180:183], v[64:67], v[140:143], v[180:183]
    v_lshl_add_u32 v238, v233, 1, v238
    s_mov_b32 s40, s30
    s_and_b32 s41, s31, 0xffff
    s_mov_b32 s42, 2621440
    s_mov_b32 s43, 0x00020000
    ds_read_b64_tr_b16 v[112:113], v234 offset:0
    ds_read_b64_tr_b16 v[114:115], v234 offset:1280
    ds_read_b64_tr_b16 v[116:117], v234 offset:32
    ds_read_b64_tr_b16 v[118:119], v234 offset:1312
    ds_read_b64_tr_b16 v[120:121], v234 offset:64
    ds_read_b64_tr_b16 v[122:123], v234 offset:1344
    ds_read_b64_tr_b16 v[124:125], v234 offset:96
    ds_read_b64_tr_b16 v[126:127], v234 offset:1376
    v_mul_f32 v164, v164, v246
    v_mul_f32 v165, v165, v246
    ds_read_b64_tr_b16 v[128:129], v234 offset:128
    ds_read_b64_tr_b16 v[130:131], v234 offset:1408
    v_mul_f32 v166, v166, v246
    v_mul_f32 v167, v167, v246
    ds_read_b64_tr_b16 v[132:133], v234 offset:6400
    ds_read_b64_tr_b16 v[134:135], v234 offset:7680
    v_mul_f32 v168, v168, v246
    v_mul_f32 v169, v169, v246
    ds_read_b64_tr_b16 v[184:185], v234 offset:6432
    ds_read_b64_tr_b16 v[186:187], v234 offset:7712
    v_mul_f32 v170, v170, v246
    v_mul_f32 v171, v171, v246
    ds_read_b64_tr_b16 v[188:189], v234 offset:6464
    s_waitcnt lgkmcnt(8)
    ds_read_b64_tr_b16 v[190:191], v234 offset:7744
    v_mul_f32 v172, v172, v246
    v_mul_f32 v173, v173, v246
    ds_read_b64_tr_b16 v[192:193], v234 offset:6496
    ds_read_b64_tr_b16 v[194:195], v234 offset:7776
    v_mul_f32 v174, v174, v246
    v_mul_f32 v175, v175, v246
    ds_read_b64_tr_b16 v[196:197], v234 offset:6528
    ds_read_b64_tr_b16 v[198:199], v234 offset:7808
    v_mul_f32 v176, v176, v246
    v_mul_f32 v177, v177, v246
    ds_read_b64_tr_b16 v[216:217], v234 offset:12800
    ds_read_b64_tr_b16 v[218:219], v234 offset:14080
    v_mul_f32 v178, v178, v246
    v_mul_f32 v179, v179, v246
    s_waitcnt lgkmcnt(8)
    ds_read_b64_tr_b16 v[220:221], v234 offset:12832
    ds_read_b64_tr_b16 v[222:223], v234 offset:14112
    v_mul_f32 v180, v180, v246
    v_mul_f32 v181, v181, v246
    ds_read_b64_tr_b16 v[228:229], v234 offset:12864
    ds_read_b64_tr_b16 v[230:231], v234 offset:14144
    v_mul_f32 v182, v182, v246
    v_mul_f32 v183, v183, v246
    ds_read_b64_tr_b16 v[204:205], v234 offset:12896
    ds_read_b64_tr_b16 v[206:207], v234 offset:14176
    ds_read_b64_tr_b16 v[80:81], v234 offset:12928
    s_waitcnt lgkmcnt(8)
    ds_read_b64_tr_b16 v[82:83], v234 offset:14208
    ds_read_b64_tr_b16 v[84:85], v234 offset:19200
    ds_read_b64_tr_b16 v[86:87], v234 offset:20480
    ds_read_b64_tr_b16 v[88:89], v234 offset:19232
    ds_read_b64_tr_b16 v[90:91], v234 offset:20512
    ds_read_b64_tr_b16 v[92:93], v234 offset:19264
    ds_read_b64_tr_b16 v[94:95], v234 offset:20544
    s_waitcnt lgkmcnt(8)
    ds_read_b64_tr_b16 v[208:209], v234 offset:19296
    ds_read_b64_tr_b16 v[210:211], v234 offset:20576
    ds_read_b64_tr_b16 v[212:213], v234 offset:19328
    ds_read_b64_tr_b16 v[214:215], v234 offset:20608
    ds_read_b64_tr_b16 v[200:201], v234 offset:25600
    ds_read_b64_tr_b16 v[202:203], v234 offset:26880
    ds_read_b64_tr_b16 v[96:97], v234 offset:25632
    s_waitcnt lgkmcnt(8)
    ds_read_b64_tr_b16 v[98:99], v234 offset:26912
    ds_read_b64_tr_b16 v[100:101], v234 offset:25664
    ds_read_b64_tr_b16 v[102:103], v234 offset:26944
    ds_read_b64_tr_b16 v[104:105], v234 offset:25696
    ds_read_b64_tr_b16 v[106:107], v234 offset:26976
    ds_read_b64_tr_b16 v[108:109], v234 offset:25728
    ds_read_b64_tr_b16 v[110:111], v234 offset:27008
    s_waitcnt vmcnt(0)
    buffer_load_dwordx4 v[8:11], v5, s[64:67], s24 offen offset:0
    buffer_load_dwordx4 v[12:15], v5, s[64:67], s24 offen offset:1024
    buffer_load_dwordx4 v[16:19], v5, s[64:67], s24 offen offset:2048
    buffer_load_dwordx4 v[20:23], v5, s[64:67], s24 offen offset:3072
    buffer_load_dwordx4 v[24:27], v5, s[64:67], s25 offen offset:0
    buffer_load_dwordx4 v[28:31], v5, s[64:67], s25 offen offset:1024
    buffer_load_dwordx4 v[32:35], v5, s[64:67], s25 offen offset:2048
    buffer_load_dwordx4 v[36:39], v5, s[64:67], s25 offen offset:3072
    buffer_load_dwordx2 v[40:41], v248, s[64:67], s26 offen offset:0
    buffer_load_dwordx2 v[42:43], v249, s[64:67], s26 offen offset:128
    buffer_load_dwordx2 v[44:45], v248, s[64:67], s26 offen offset:1024
    buffer_load_dwordx2 v[46:47], v249, s[64:67], s26 offen offset:1152
    s_mov_b32 s17, 0
    s_waitcnt lgkmcnt(8)
    ds_read_b64_tr_b16 v[48:49], v234 offset:32000
    ds_read_b64_tr_b16 v[50:51], v234 offset:33280
    ds_read_b64_tr_b16 v[52:53], v234 offset:32032
    ds_read_b64_tr_b16 v[54:55], v234 offset:33312
    ds_read_b64_tr_b16 v[56:57], v234 offset:32064
    ds_read_b64_tr_b16 v[58:59], v234 offset:33344
    ds_read_b64_tr_b16 v[60:61], v234 offset:32096
    s_waitcnt lgkmcnt(8)
    ds_read_b64_tr_b16 v[62:63], v234 offset:33376
    ds_read_b64_tr_b16 v[64:65], v234 offset:32128
    ds_read_b64_tr_b16 v[66:67], v234 offset:33408
    ds_read_b64_tr_b16 v[68:69], v234 offset:38400
    ds_read_b64_tr_b16 v[70:71], v234 offset:39680
    ds_read_b64_tr_b16 v[72:73], v234 offset:38432
    ds_read_b64_tr_b16 v[74:75], v234 offset:39712
    s_waitcnt lgkmcnt(8)
    ds_read_b64_tr_b16 v[76:77], v234 offset:38464
    ds_read_b64_tr_b16 v[78:79], v234 offset:39744
    ds_read_b64_tr_b16 v[136:137], v234 offset:38496
    ds_read_b64_tr_b16 v[138:139], v234 offset:39776
    ds_read_b64_tr_b16 v[140:141], v234 offset:38528
    ds_read_b64_tr_b16 v[142:143], v234 offset:39808
    ds_read_b64_tr_b16 v[144:145], v234 offset:44800
    s_waitcnt lgkmcnt(8)
    ds_read_b64_tr_b16 v[146:147], v234 offset:46080
    ds_read_b64_tr_b16 v[148:149], v234 offset:44832
    ds_read_b64_tr_b16 v[150:151], v234 offset:46112
    ds_read_b64_tr_b16 v[152:153], v234 offset:44864
    ds_read_b64_tr_b16 v[154:155], v234 offset:46144
    ds_read_b64_tr_b16 v[156:157], v234 offset:44896
    ds_read_b64_tr_b16 v[158:159], v234 offset:46176
    s_waitcnt lgkmcnt(8)
    ds_read_b64_tr_b16 v[160:161], v234 offset:44928
    ds_read_b64_tr_b16 v[162:163], v234 offset:46208
t_jn:
    s_waitcnt vmcnt(11)
    v_max3_u32 v232, v8, v9, v10
    v_max_u32 v232, v232, v11
    v_cmp_eq_u32 vcc, -1, v232
    s_nop 0
    s_cbranch_vccnz t_rt0
t_bk0:
    v_mfma_f32_16x16x32_bf16 v[164:167], v[112:115], v[8:11], v[164:167]
    ds_read_b64_tr_b16 v[112:113], v235 offset:2560
    ds_read_b64_tr_b16 v[114:115], v236 offset:5760
    v_mfma_f32_16x16x32_bf16 v[168:171], v[116:119], v[8:11], v[168:171]
    s_waitcnt vmcnt(10)
    v_max3_u32 v232, v12, v13, v14
    ds_read_b64_tr_b16 v[116:117], v235 offset:2592
    ds_read_b64_tr_b16 v[118:119], v236 offset:5792
    v_mfma_f32_16x16x32_bf16 v[172:175], v[120:123], v[8:11], v[172:175]
    v_max_u32 v232, v232, v15
    v_cmp_eq_u32 vcc, -1, v232
    ds_read_b64_tr_b16 v[120:121], v235 offset:2624
    s_waitcnt lgkmcnt(8)
    ds_read_b64_tr_b16 v[122:123], v236 offset:5824
    v_mfma_f32_16x16x32_bf16 v[176:179], v[124:127], v[8:11], v[176:179]
    s_cbranch_vccnz t_rt1
t_bk1:
    ds_read_b64_tr_b16 v[124:125], v235 offset:2656
    ds_read_b64_tr_b16 v[126:127], v236 offset:5856
    v_mfma_f32_16x16x32_bf16 v[180:183], v[128:131], v[8:11], v[180:183]
    ds_read_b64_tr_b16 v[128:129], v235 offset:2688
    ds_read_b64_tr_b16 v[130:131], v236 offset:5888
    v_mfma_f32_16x16x32_bf16 v[164:167], v[132:135], v[12:15], v[164:167]
    ds_read_b64_tr_b16 v[132:133], v235 offset:28160
    ds_read_b64_tr_b16 v[134:135], v236 offset:31360
    v_mfma_f32_16x16x32_bf16 v[168:171], v[184:187], v[12:15], v[168:171]
    s_waitcnt vmcnt(9)
    v_max3_u32 v232, v16, v17, v18
    s_waitcnt lgkmcnt(8)
    ds_read_b64_tr_b16 v[184:185], v235 offset:28192
    ds_read_b64_tr_b16 v[186:187], v236 offset:31392
    v_mfma_f32_16x16x32_bf16 v[172:175], v[188:191], v[12:15], v[172:175]
    v_max_u32 v232, v232, v19
    v_cmp_eq_u32 vcc, -1, v232
    ds_read_b64_tr_b16 v[188:189], v235 offset:28224
    ds_read_b64_tr_b16 v[190:191], v236 offset:31424
    v_mfma_f32_16x16x32_bf16 v[176:179], v[192:195], v[12:15], v[176:179]
    s_cbranch_vccnz t_rt2
t_bk2:
    ds_read_b64_tr_b16 v[192:193], v235 offset:28256
    ds_read_b64_tr_b16 v[194:195], v236 offset:31456
    v_mfma_f32_16x16x32_bf16 v[180:183], v[196:199], v[12:15], v[180:183]
    ds_read_b64_tr_b16 v[196:197], v235 offset:28288
    s_waitcnt lgkmcnt(8)
    ds_read_b64_tr_b16 v[198:199], v236 offset:31488
    v_mfma_f32_16x16x32_bf16 v[164:167], v[216:219], v[16:19], v[164:167]
    v_mfma_f32_16x16x32_bf16 v[168:171], v[220:223], v[16:19], v[168:171]
    s_waitcnt vmcnt(8)
    v_max3_u32 v232, v20, v21, v22
    v_mfma_f32_16x16x32_bf16 v[172:175], v[228:231], v[16:19], v[172:175]
    v_max_u32 v232, v232, v23
    v_cmp_eq_u32 vcc, -1, v232
    v_mfma_f32_16x16x32_bf16 v[176:179], v[204:207], v[16:19], v[176:179]
    s_cbranch_vccnz t_rt3
t_bk3:
    v_mfma_f32_16x16x32_bf16 v[180:183], v[80:83], v[16:19], v[180:183]
    v_mfma_f32_16x16x32_bf16 v[164:167], v[84:87], v[20:23], v[164:167]
    v_mfma_f32_16x16x32_bf16 v[168:171], v[88:91], v[20:23], v[168:171]
    s_waitcnt vmcnt(7)
    v_max3_u32 v232, v24, v25, v26
    v_mfma_f32_16x16x32_bf16 v[172:175], v[92:95], v[20:23], v[172:175]
    v_max_u32 v232, v232, v27
    v_cmp_eq_u32 vcc, -1, v232
    v_mfma_f32_16x16x32_bf16 v[176:179], v[208:211], v[20:23], v[176:179]
    s_cbranch_vccnz t_rt4
t_bk4:
    v_mfma_f32_16x16x32_bf16 v[180:183], v[212:215], v[20:23], v[180:183]
    v_mfma_f32_16x16x32_bf16 v[164:167], v[200:203], v[24:27], v[164:167]
    v_mfma_f32_16x16x32_bf16 v[168:171], v[96:99], v[24:27], v[168:171]
    s_waitcnt vmcnt(6)
    v_max3_u32 v232, v28, v29, v30
    v_mfma_f32_16x16x32_bf16 v[172:175], v[100:103], v[24:27], v[172:175]
    v_max_u32 v232, v232, v31
    v_cmp_eq_u32 vcc, -1, v232
    v_mfma_f32_16x16x32_bf16 v[176:179], v[104:107], v[24:27], v[176:179]
    s_cbranch_vccnz t_rt5
t_bk5:
    v_mfma_f32_16x16x32_bf16 v[180:183], v[108:111], v[24:27], v[180:183]
    v_mfma_f32_16x16x32_bf16 v[164:167], v[48:51], v[28:31], v[164:167]
    v_mfma_f32_16x16x32_bf16 v[168:171], v[52:55], v[28:31], v[168:171]
    s_waitcnt vmcnt(5)
    v_max3_u32 v232, v32, v33, v34
    v_mfma_f32_16x16x32_bf16 v[172:175], v[56:59], v[28:31], v[172:175]
    v_max_u32 v232, v232, v35
    v_cmp_eq_u32 vcc, -1, v232
    v_mfma_f32_16x16x32_bf16 v[176:179], v[60:63], v[28:31], v[176:179]
    s_cbranch_vccnz t_rt6
t_bk6:
    v_mfma_f32_16x16x32_bf16 v[180:183], v[64:67], v[28:31], v[180:183]
    v_mfma_f32_16x16x32_bf16 v[164:167], v[68:71], v[32:35], v[164:167]
    v_mfma_f32_16x16x32_bf16 v[168:171], v[72:75], v[32:35], v[168:171]
    s_waitcnt vmcnt(4)
    v_max3_u32 v232, v36, v37, v38
    v_mfma_f32_16x16x32_bf16 v[172:175], v[76:79], v[32:35], v[172:175]
    v_max_u32 v232, v232, v39
    v_cmp_eq_u32 vcc, -1, v232
    v_mfma_f32_16x16x32_bf16 v[176:179], v[136:139], v[32:35], v[176:179]
    s_cbranch_vccnz t_rt7
t_bk7:
    v_mfma_f32_16x16x32_bf16 v[180:183], v[140:143], v[32:35], v[180:183]
    v_mfma_f32_16x16x32_bf16 v[164:167], v[144:147], v[36:39], v[164:167]
    v_mfma_f32_16x16x32_bf16 v[168:171], v[148:151], v[36:39], v[168:171]
    s_waitcnt vmcnt(2)
    v_max3_u32 v232, v40, v41, v42
    v_mfma_f32_16x16x32_bf16 v[172:175], v[152:155], v[36:39], v[172:175]
    v_max_u32 v232, v232, v43
    v_cmp_eq_u32 vcc, -1, v232
    v_mfma_f32_16x16x32_bf16 v[176:179], v[156:159], v[36:39], v[176:179]
    s_cbranch_vccnz t_rt8
t_bk8:
    v_mfma_f32_16x16x32_bf16 v[180:183], v[160:163], v[36:39], v[180:183]
    v_mfma_f32_16x16x32_bf16 v[164:167], v[112:115], v[40:43], v[164:167]
    v_mfma_f32_16x16x32_bf16 v[168:171], v[116:119], v[40:43], v[168:171]
    s_waitcnt vmcnt(0)
    v_max3_u32 v232, v44, v45, v46
    v_mfma_f32_16x16x32_bf16 v[172:175], v[120:123], v[40:43], v[172:175]
    v_max_u32 v232, v232, v47
    v_cmp_eq_u32 vcc, -1, v232
    v_mfma_f32_16x16x32_bf16 v[176:179], v[124:127], v[40:43], v[176:179]
    s_cbranch_vccnz t_rt9
t_bk9:
    v_mfma_f32_16x16x32_bf16 v[180:183], v[128:131], v[40:43], v[180:183]
    s_cmp_lg_u32 s35, 0
    s_cbranch_scc1 t_h1
    s_waitcnt lgkmcnt(4)
    v_mfma_f32_16x16x32_bf16 v[172:175], v[188:191], v[44:47], v[172:175]
    s_waitcnt lgkmcnt(2)
    v_mfma_f32_16x16x32_bf16 v[176:179], v[192:195], v[44:47], v[176:179]
    v_mfma_f32_16x16x32_bf16 v[164:167], v[132:135], v[44:47], v[164:167]
    v_mfma_f32_16x16x32_bf16 v[168:171], v[184:187], v[44:47], v[168:171]
    s_waitcnt lgkmcnt(0)
    v_mfma_f32_16x16x32_bf16 v[180:183], v[196:199], v[44:47], v[180:183]
    s_nop 1
    ds_write_b128 v241, v[172:175] offset:3072
    s_nop 0
    ds_write_b128 v241, v[176:179] offset:4096
    ds_write_b32 v250, v250 offset:0
t_fl0:
    ds_read_b32 v233, v250 offset:16
    ds_read_b128 v[84:87], v240 offset:0
    ds_read_b128 v[88:91], v240 offset:1024
    ds_read_b128 v[212:215], v240 offset:2048
    s_add_u32 s17, s17, 1
    s_cmp_gt_u32 s17, 16777216
    s_waitcnt lgkmcnt(3)
    v_cmp_eq_u32 vcc, 0, v233
    s_cbranch_scc1 t_fm0
    s_cbranch_vccnz t_fl0
t_fm0:
    s_waitcnt lgkmcnt(2)
    v_add_f32 v164, v164, v84
    v_add_f32 v165, v165, v85
    v_add_f32 v166, v166, v86
    v_add_f32 v167, v167, v87
    v_cvt_pk_bf16_f32 v164, v164, v165
    v_cvt_pk_bf16_f32 v165, v166, v167
    s_waitcnt lgkmcnt(1)
    v_add_f32 v168, v168, v88
    v_add_f32 v169, v169, v89
    v_add_f32 v170, v170, v90
    v_add_f32 v171, v171, v91
    v_cvt_pk_bf16_f32 v166, v168, v169
    v_cvt_pk_bf16_f32 v167, v170, v171
    s_nop 0
    v_permlane16_swap_b32 v164, v166
    v_permlane16_swap_b32 v165, v167
    buffer_store_dwordx4 v[164:167], v238, s[40:43], 0 offen offset:0
    s_waitcnt lgkmcnt(0)
    v_add_f32 v180, v180, v212
    v_add_f32 v181, v181, v213
    v_add_f32 v182, v182, v214
    v_add_f32 v183, v183, v215
    v_cvt_pk_bf16_f32 v180, v180, v181
    v_cvt_pk_bf16_f32 v181, v182, v183
    buffer_store_dwordx2 v[180:181], v237, s[40:43], 0 offen offset:128
    s_endpgm
t_h1:
    s_waitcnt lgkmcnt(8)
    v_mfma_f32_16x16x32_bf16 v[164:167], v[132:135], v[44:47], v[164:167]
    s_waitcnt lgkmcnt(6)
    v_mfma_f32_16x16x32_bf16 v[168:171], v[184:187], v[44:47], v[168:171]
    s_waitcnt lgkmcnt(0)
    v_mfma_f32_16x16x32_bf16 v[180:183], v[196:199], v[44:47], v[180:183]
    v_mfma_f32_16x16x32_bf16 v[172:175], v[188:191], v[44:47], v[172:175]
    v_mfma_f32_16x16x32_bf16 v[176:179], v[192:195], v[44:47], v[176:179]
    s_nop 1
    ds_write_b128 v240, v[164:167] offset:0
    s_nop 0
    ds_write_b128 v240, v[168:171] offset:1024
    s_nop 0
    ds_write_b128 v240, v[180:183] offset:2048
    ds_write_b32 v250, v250 offset:16
t_fl1:
    ds_read_b32 v233, v250 offset:0
    ds_read_b128 v[92:95], v241 offset:3072
    ds_read_b128 v[208:211], v241 offset:4096
    s_add_u32 s17, s17, 1
    s_cmp_gt_u32 s17, 16777216
    s_waitcnt lgkmcnt(2)
    v_cmp_eq_u32 vcc, 0, v233
    s_cbranch_scc1 t_fm1
    s_cbranch_vccnz t_fl1
t_fm1:
    s_waitcnt lgkmcnt(1)
    v_add_f32 v172, v172, v92
    v_add_f32 v173, v173, v93
    v_add_f32 v174, v174, v94
    v_add_f32 v175, v175, v95
    v_cvt_pk_bf16_f32 v172, v172, v173
    v_cvt_pk_bf16_f32 v173, v174, v175
    s_waitcnt lgkmcnt(0)
    v_add_f32 v176, v176, v208
    v_add_f32 v177, v177, v209
    v_add_f32 v178, v178, v210
    v_add_f32 v179, v179, v211
    v_cvt_pk_bf16_f32 v174, v176, v177
    v_cvt_pk_bf16_f32 v175, v178, v179
    s_nop 0
    v_permlane16_swap_b32 v172, v174
    v_permlane16_swap_b32 v173, v175
    buffer_store_dwordx4 v[172:175], v238, s[40:43], 0 offen offset:64
    s_endpgm
t_ld:
    s_setprio 0
    ds_read2st64_b32 v[144:145], v224 offset0:0 offset1:5
    ds_read2st64_b32 v[146:147], v224 offset0:10 offset1:15
    ds_read2st64_b32 v[48:49], v224 offset0:20 offset1:25
    ds_read2st64_b32 v[50:51], v224 offset0:30 offset1:35
    v_add_u32 v224, s27, v224
    ds_read2st64_b32 v[148:149], v224 offset0:0 offset1:5
    ds_read2st64_b32 v[150:151], v224 offset0:10 offset1:15
    ds_read2st64_b32 v[52:53], v224 offset0:20 offset1:25
    ds_read2st64_b32 v[54:55], v224 offset0:30 offset1:35
    v_add_u32 v224, s27, v224
    ds_read2st64_b32 v[152:153], v224 offset0:0 offset1:5
    ds_read2st64_b32 v[154:155], v224 offset0:10 offset1:15
    ds_read2st64_b32 v[56:57], v224 offset0:20 offset1:25
    ds_read2st64_b32 v[58:59], v224 offset0:30 offset1:35
    v_add_u32 v224, s27, v224
    ds_read2st64_b32 v[156:157], v224 offset0:0 offset1:5
    ds_read2st64_b32 v[158:159], v224 offset0:10 offset1:15
    ds_read2st64_b32 v[60:61], v224 offset0:20 offset1:25
    s_waitcnt lgkmcnt(8)
    ds_read2st64_b32 v[62:63], v224 offset0:30 offset1:35
    v_add_u32 v224, s27, v224
    ds_read2st64_b32 v[160:161], v224 offset0:0 offset1:5
    ds_read2st64_b32 v[162:163], v224 offset0:10 offset1:15
    ds_read2st64_b32 v[64:65], v224 offset0:20 offset1:25
    ds_read2st64_b32 v[66:67], v224 offset0:30 offset1:35
    v_mfma_f32_16x16x32_bf16 v[164:167], v[144:147], v[136:139], 0
    s_mul_i32 s3, s34, 3072
    s_add_u32 s3, s3, 139264
    s_cmp_eq_u32 s34, 3
    v_mfma_f32_16x16x32_bf16 v[164:167], v[48:51], v[140:143], v[164:167]
    s_cselect_b32 s3, 129024, s3
    v_add_u32 v240, s3, v5
    s_lshl_b32 s3, s34, 11
    v_mfma_f32_16x16x32_bf16 v[168:171], v[148:151], v[136:139], 0
    s_add_u32 s3, s3, 145408
    v_add_u32 v241, s3, v5
    v_sub_f32 v246, 1.0, v246
    s_waitcnt lgkmcnt(12)
    v_mfma_f32_16x16x32_bf16 v[168:171], v[52:55], v[140:143], v[168:171]
    v_cvt_pk_bf16_f32 v246, v246, v246
    v_lshlrev_b32 v246, 16, v246
    s_cmp_lt_u32 s94, 4
    s_waitcnt lgkmcnt(10)
    v_mfma_f32_16x16x32_bf16 v[172:175], v[152:155], v[136:139], 0
    s_cselect_b32 s3, s35, 0
    s_lshl_b32 s3, s3, 31
    v_xor_b32 v246, s3, v246
    s_waitcnt lgkmcnt(8)
    v_mfma_f32_16x16x32_bf16 v[172:175], v[56:59], v[140:143], v[172:175]
    s_and_b32 s3, s97, 1
    s_lshl_b32 s3, s3, 5
    s_add_u32 s3, s3, s96
    s_waitcnt lgkmcnt(6)
    v_mfma_f32_16x16x32_bf16 v[176:179], v[156:159], v[136:139], 0
    s_mul_i32 s3, s3, 40960
    s_add_u32 s3, s3, s95
    s_mul_i32 s4, s94, 160
    s_waitcnt lgkmcnt(4)
    v_mfma_f32_16x16x32_bf16 v[176:179], v[60:63], v[140:143], v[176:179]
    s_add_u32 s3, s3, s4
    v_mul_u32_u24 v237, 81920, v3
    v_add_u32 v237, s3, v237
    s_waitcnt lgkmcnt(2)
    v_mfma_f32_16x16x32_bf16 v[180:183], v[160:163], v[136:139], 0
    v_lshl_add_u32 v238, v2, 4, v237
    v_lshl_add_u32 v237, v4, 3, v237
    v_and_b32 v233, 16, v0
    s_waitcnt lgkmcnt(0)
    v_mfma_f32_16x16x32_bf16 v[180:183], v[64:67], v[140:143], v[180:183]
    v_lshl_add_u32 v238, v233, 1, v238
    s_mov_b32 s40, s30
    s_and_b32 s41, s31, 0xffff
    s_mov_b32 s42, 2621440
    s_mov_b32 s43, 0x00020000
    ds_read_b64_tr_b16 v[112:113], v234 offset:0
    ds_read_b64_tr_b16 v[114:115], v234 offset:1280
    ds_read_b64_tr_b16 v[116:117], v234 offset:32
    ds_read_b64_tr_b16 v[118:119], v234 offset:1312
    ds_read_b64_tr_b16 v[120:121], v234 offset:64
    ds_read_b64_tr_b16 v[122:123], v234 offset:1344
    ds_read_b64_tr_b16 v[124:125], v234 offset:96
    ds_read_b64_tr_b16 v[126:127], v234 offset:1376
    v_mul_f32 v164, v164, v246
    v_mul_f32 v165, v165, v246
    ds_read_b64_tr_b16 v[128:129], v234 offset:128
    ds_read_b64_tr_b16 v[130:131], v234 offset:1408
    v_mul_f32 v166, v166, v246
    v_mul_f32 v167, v167, v246
    ds_read_b64_tr_b16 v[132:133], v234 offset:6400
    ds_read_b64_tr_b16 v[134:135], v234 offset:7680
    v_mul_f32 v168, v168, v246
    v_mul_f32 v169, v169, v246
    ds_read_b64_tr_b16 v[184:185], v234 offset:6432
    ds_read_b64_tr_b16 v[186:187], v234 offset:7712
    v_mul_f32 v170, v170, v246
    v_mul_f32 v171, v171, v246
    ds_read_b64_tr_b16 v[188:189], v234 offset:6464
    s_waitcnt lgkmcnt(8)
    ds_read_b64_tr_b16 v[190:191], v234 offset:7744
    v_mul_f32 v172, v172, v246
    v_mul_f32 v173, v173, v246
    ds_read_b64_tr_b16 v[192:193], v234 offset:6496
    ds_read_b64_tr_b16 v[194:195], v234 offset:7776
    v_mul_f32 v174, v174, v246
    v_mul_f32 v175, v175, v246
    ds_read_b64_tr_b16 v[196:197], v234 offset:6528
    ds_read_b64_tr_b16 v[198:199], v234 offset:7808
    v_mul_f32 v176, v176, v246
    v_mul_f32 v177, v177, v246
    ds_read_b64_tr_b16 v[216:217], v234 offset:12800
    ds_read_b64_tr_b16 v[218:219], v234 offset:14080
    v_mul_f32 v178, v178, v246
    v_mul_f32 v179, v179, v246
    s_waitcnt lgkmcnt(8)
    ds_read_b64_tr_b16 v[220:221], v234 offset:12832
    ds_read_b64_tr_b16 v[222:223], v234 offset:14112
    v_mul_f32 v180, v180, v246
    v_mul_f32 v181, v181, v246
    ds_read_b64_tr_b16 v[228:229], v234 offset:12864
    ds_read_b64_tr_b16 v[230:231], v234 offset:14144
    v_mul_f32 v182, v182, v246
    v_mul_f32 v183, v183, v246
    ds_read_b64_tr_b16 v[204:205], v234 offset:12896
    ds_read_b64_tr_b16 v[206:207], v234 offset:14176
    ds_read_b64_tr_b16 v[80:81], v234 offset:12928
    s_waitcnt lgkmcnt(8)
    ds_read_b64_tr_b16 v[82:83], v234 offset:14208
    ds_read_b64_tr_b16 v[84:85], v234 offset:19200
    ds_read_b64_tr_b16 v[86:87], v234 offset:20480
    ds_read_b64_tr_b16 v[88:89], v234 offset:19232
    ds_read_b64_tr_b16 v[90:91], v234 offset:20512
    ds_read_b64_tr_b16 v[92:93], v234 offset:19264
    ds_read_b64_tr_b16 v[94:95], v234 offset:20544
    s_waitcnt lgkmcnt(8)
    ds_read_b64_tr_b16 v[208:209], v234 offset:19296
    ds_read_b64_tr_b16 v[210:211], v234 offset:20576
    ds_read_b64_tr_b16 v[212:213], v234 offset:19328
    ds_read_b64_tr_b16 v[214:215], v234 offset:20608
    ds_read_b64_tr_b16 v[200:201], v234 offset:25600
    ds_read_b64_tr_b16 v[202:203], v234 offset:26880
    ds_read_b64_tr_b16 v[96:97], v234 offset:25632
    s_waitcnt lgkmcnt(8)
    ds_read_b64_tr_b16 v[98:99], v234 offset:26912
    ds_read_b64_tr_b16 v[100:101], v234 offset:25664
    ds_read_b64_tr_b16 v[102:103], v234 offset:26944
    ds_read_b64_tr_b16 v[104:105], v234 offset:25696
    ds_read_b64_tr_b16 v[106:107], v234 offset:26976
    ds_read_b64_tr_b16 v[108:109], v234 offset:25728
    ds_read_b64_tr_b16 v[110:111], v234 offset:27008
    s_waitcnt lgkmcnt(8)
    ds_read_b64_tr_b16 v[48:49], v234 offset:32000
    ds_read_b64_tr_b16 v[50:51], v234 offset:33280
    ds_read_b64_tr_b16 v[52:53], v234 offset:32032
    ds_read_b64_tr_b16 v[54:55], v234 offset:33312
    ds_read_b64_tr_b16 v[56:57], v234 offset:32064
    ds_read_b64_tr_b16 v[58:59], v234 offset:33344
    ds_read_b64_tr_b16 v[60:61], v234 offset:32096
    s_waitcnt lgkmcnt(8)
    ds_read_b64_tr_b16 v[62:63], v234 offset:33376
    ds_read_b64_tr_b16 v[64:65], v234 offset:32128
    ds_read_b64_tr_b16 v[66:67], v234 offset:33408
    s_barrier
    s_waitcnt vmcnt(0)
    buffer_load_dwordx4 v[8:11], v5, s[64:67], s24 offen offset:0
    buffer_load_dwordx4 v[12:15], v5, s[64:67], s24 offen offset:1024
    buffer_load_dwordx4 v[16:19], v5, s[64:67], s24 offen offset:2048
    buffer_load_dwordx4 v[20:23], v5, s[64:67], s24 offen offset:3072
    buffer_load_dwordx4 v[24:27], v5, s[64:67], s25 offen offset:0
    buffer_load_dwordx4 v[28:31], v5, s[64:67], s25 offen offset:1024
    buffer_load_dwordx4 v[32:35], v5, s[64:67], s25 offen offset:2048
    buffer_load_dwordx4 v[36:39], v5, s[64:67], s25 offen offset:3072
    buffer_load_dwordx2 v[40:41], v248, s[64:67], s26 offen offset:0
    buffer_load_dwordx2 v[42:43], v249, s[64:67], s26 offen offset:128
    buffer_load_dwordx2 v[44:45], v248, s[64:67], s26 offen offset:1024
    buffer_load_dwordx2 v[46:47], v249, s[64:67], s26 offen offset:1152
    s_mov_b32 s17, 0
    ds_read_b64_tr_b16 v[68:69], v234 offset:38400
    ds_read_b64_tr_b16 v[70:71], v234 offset:39680
    ds_read_b64_tr_b16 v[72:73], v234 offset:38432
    ds_read_b64_tr_b16 v[74:75], v234 offset:39712
    s_waitcnt lgkmcnt(8)
    ds_read_b64_tr_b16 v[76:77], v234 offset:38464
    ds_read_b64_tr_b16 v[78:79], v234 offset:39744
    ds_read_b64_tr_b16 v[136:137], v234 offset:38496
    ds_read_b64_tr_b16 v[138:139], v234 offset:39776
    ds_read_b64_tr_b16 v[140:141], v234 offset:38528
    ds_read_b64_tr_b16 v[142:143], v234 offset:39808
    ds_read_b64_tr_b16 v[144:145], v234 offset:44800
    s_waitcnt lgkmcnt(8)
    ds_read_b64_tr_b16 v[146:147], v234 offset:46080
    ds_read_b64_tr_b16 v[148:149], v234 offset:44832
    ds_read_b64_tr_b16 v[150:151], v234 offset:46112
    ds_read_b64_tr_b16 v[152:153], v234 offset:44864
    ds_read_b64_tr_b16 v[154:155], v234 offset:46144
    ds_read_b64_tr_b16 v[156:157], v234 offset:44896
    ds_read_b64_tr_b16 v[158:159], v234 offset:46176
    s_waitcnt lgkmcnt(8)
    ds_read_b64_tr_b16 v[160:161], v234 offset:44928
    ds_read_b64_tr_b16 v[162:163], v234 offset:46208
    s_branch t_jn
t_rt0:
    s_mov_b32 s98, 0
    s_branch t_rtc
t_rt1:
    s_mov_b32 s98, 1
    s_branch t_rtc
t_rt2:
    s_mov_b32 s98, 2
    s_branch t_rtc
t_rt3:
    s_mov_b32 s98, 3
    s_branch t_rtc
t_rt4:
    s_mov_b32 s98, 4
    s_branch t_rtc
t_rt5:
    s_mov_b32 s98, 5
    s_branch t_rtc
t_rt6:
    s_mov_b32 s98, 6
    s_branch t_rtc
t_rt7:
    s_mov_b32 s98, 7
    s_branch t_rtc
t_rt8:
    s_mov_b32 s98, 8
    s_branch t_rtc
t_rt9:
    s_mov_b32 s98, 9
    s_branch t_rtc
t_rtc:
    s_waitcnt vmcnt(0) lgkmcnt(0)
    s_mov_b32 s99, 0
    v_max3_u32 v232, v8, v9, v10
    v_max_u32 v232, v232, v11
    v_cmp_eq_u32 vcc, -1, v232
    s_nop 0
    s_cbranch_vccz t_rs0
    buffer_load_dwordx4 v[8:11], v5, s[64:67], s24 offen offset:0 sc1
    s_mov_b32 s99, 1
t_rs0:
    v_max3_u32 v232, v12, v13, v14
    v_max_u32 v232, v232, v15
    v_cmp_eq_u32 vcc, -1, v232
    s_nop 0
    s_cbranch_vccz t_rs1
    buffer_load_dwordx4 v[12:15], v5, s[64:67], s24 offen offset:1024 sc1
    s_mov_b32 s99, 1
t_rs1:
    v_max3_u32 v232, v16, v17, v18
    v_max_u32 v232, v232, v19
    v_cmp_eq_u32 vcc, -1, v232
    s_nop 0
    s_cbranch_vccz t_rs2
    buffer_load_dwordx4 v[16:19], v5, s[64:67], s24 offen offset:2048 sc1
    s_mov_b32 s99, 1
t_rs2:
    v_max3_u32 v232, v20, v21, v22
    v_max_u32 v232, v232, v23
    v_cmp_eq_u32 vcc, -1, v232
    s_nop 0
    s_cbranch_vccz t_rs3
    buffer_load_dwordx4 v[20:23], v5, s[64:67], s24 offen offset:3072 sc1
    s_mov_b32 s99, 1
t_rs3:
    v_max3_u32 v232, v24, v25, v26
    v_max_u32 v232, v232, v27
    v_cmp_eq_u32 vcc, -1, v232
    s_nop 0
    s_cbranch_vccz t_rs4
    buffer_load_dwordx4 v[24:27], v5, s[64:67], s25 offen offset:0 sc1
    s_mov_b32 s99, 1
t_rs4:
    v_max3_u32 v232, v28, v29, v30
    v_max_u32 v232, v232, v31
    v_cmp_eq_u32 vcc, -1, v232
    s_nop 0
    s_cbranch_vccz t_rs5
    buffer_load_dwordx4 v[28:31], v5, s[64:67], s25 offen offset:1024 sc1
    s_mov_b32 s99, 1
t_rs5:
    v_max3_u32 v232, v32, v33, v34
    v_max_u32 v232, v232, v35
    v_cmp_eq_u32 vcc, -1, v232
    s_nop 0
    s_cbranch_vccz t_rs6
    buffer_load_dwordx4 v[32:35], v5, s[64:67], s25 offen offset:2048 sc1
    s_mov_b32 s99, 1
t_rs6:
    v_max3_u32 v232, v36, v37, v38
    v_max_u32 v232, v232, v39
    v_cmp_eq_u32 vcc, -1, v232
    s_nop 0
    s_cbranch_vccz t_rs7
    buffer_load_dwordx4 v[36:39], v5, s[64:67], s25 offen offset:3072 sc1
    s_mov_b32 s99, 1
t_rs7:
    v_max3_u32 v232, v40, v41, v42
    v_max_u32 v232, v232, v43
    v_cmp_eq_u32 vcc, -1, v232
    s_nop 0
    s_cbranch_vccz t_rs8
    buffer_load_dwordx2 v[40:41], v248, s[64:67], s26 offen offset:0 sc1
    buffer_load_dwordx2 v[42:43], v249, s[64:67], s26 offen offset:128 sc1
    s_mov_b32 s99, 1
t_rs8:
    v_max3_u32 v232, v44, v45, v46
    v_max_u32 v232, v232, v47
    v_cmp_eq_u32 vcc, -1, v232
    s_nop 0
    s_cbranch_vccz t_rs9
    buffer_load_dwordx2 v[44:45], v248, s[64:67], s26 offen offset:1024 sc1
    buffer_load_dwordx2 v[46:47], v249, s[64:67], s26 offen offset:1152 sc1
    s_mov_b32 s99, 1
t_rs9:
    s_add_u32 s17, s17, 1
    s_cmp_gt_u32 s17, 1048576
    s_cselect_b32 s99, 0, s99
    s_cmp_lg_u32 s99, 0
    s_cbranch_scc1 t_rtc
    s_waitcnt vmcnt(0) lgkmcnt(0)
    s_cmp_eq_u32 s98, 0
    s_cbranch_scc1 t_bk0
    s_cmp_eq_u32 s98, 1
    s_cbranch_scc1 t_bk1
    s_cmp_eq_u32 s98, 2
    s_cbranch_scc1 t_bk2
    s_cmp_eq_u32 s98, 3
    s_cbranch_scc1 t_bk3
    s_cmp_eq_u32 s98, 4
    s_cbranch_scc1 t_bk4
    s_cmp_eq_u32 s98, 5
    s_cbranch_scc1 t_bk5
    s_cmp_eq_u32 s98, 6
    s_cbranch_scc1 t_bk6
    s_cmp_eq_u32 s98, 7
    s_cbranch_scc1 t_bk7
    s_cmp_eq_u32 s98, 8
    s_cbranch_scc1 t_bk8
    s_branch t_bk9
t_fallback:
    v_lshlrev_b32 v244, 3, v0
    v_cmp_eq_u32 vcc, 0, v2
    v_min_u32 v245, 23, v1
    v_mul_u32_u24 v243, 24, v2
    v_add_lshl_u32 v245, v245, v243, 4
    v_cndmask_b32 v20, 0, v20, vcc
    v_cndmask_b32 v21, 0, v21, vcc
    v_mov_b32 v243, 0xff800000
    s_mov_b32 s18, 0
t_fb1:
    buffer_load_dwordx4 v[24:27], v5, s[64:67], s18 offen sc1
    buffer_load_dwordx2 v[22:23], v244, s[64:67], s18 offen offset:2560 sc1
    s_waitcnt vmcnt(1)
    v_mfma_f32_32x32x16_bf16 v[32:47], v[24:27], v[16:19], 0
    s_waitcnt vmcnt(0)
    v_mfma_f32_32x32x8_bf16 v[32:47], v[22:23], v[20:21], v[32:47]
    s_nop 7
    s_nop 3
    v_max3_f32 v243, v243, v32, v33
    v_max3_f32 v243, v243, v34, v35
    v_max3_f32 v243, v243, v36, v37
    v_max3_f32 v243, v243, v38, v39
    v_max3_f32 v243, v243, v40, v41
    v_max3_f32 v243, v243, v42, v43
    v_max3_f32 v243, v243, v44, v45
    v_max3_f32 v243, v243, v46, v47
    s_add_u32 s18, s18, 3072
    s_cmp_lt_u32 s18, 196608
    s_cbranch_scc1 t_fb1
    v_mov_b32 v44, v243
    v_cmp_eq_u32 vcc, 0, v2
    s_nop 0
    v_permlane32_swap_b32 v243, v44
    v_max_f32 v243, v243, v44
    v_sub_f32 v40, 0, v243
    v_and_b32 v41, 0xffff0000, v40
    v_sub_f32 v42, v40, v41
    v_and_b32 v43, 0xffff0000, v42
    v_sub_f32 v42, v42, v43
    v_cvt_pk_bf16_f32 v42, v42, v42
    v_and_b32 v42, 0xffff, v42
    v_lshrrev_b32 v41, 16, v41
    v_or_b32 v41, v41, v43
    v_cndmask_b32 v20, v41, v20, vcc
    v_cndmask_b32 v21, v42, v21, vcc
    v_mov_b32 v96, 0
    v_mov_b32 v97, 0
    v_mov_b32 v98, 0
    v_mov_b32 v99, 0
    v_mov_b32 v100, 0
    v_mov_b32 v101, 0
    v_mov_b32 v102, 0
    v_mov_b32 v103, 0
    v_mov_b32 v104, 0
    v_mov_b32 v105, 0
    v_mov_b32 v106, 0
    v_mov_b32 v107, 0
    v_mov_b32 v108, 0
    v_mov_b32 v109, 0
    v_mov_b32 v110, 0
    v_mov_b32 v111, 0
    s_mov_b32 s18, 0
t_fb2:
    buffer_load_dwordx4 v[24:27], v5, s[64:67], s18 offen sc1
    buffer_load_dwordx2 v[22:23], v244, s[64:67], s18 offen offset:2560 sc1
    buffer_load_dwordx4 v[28:31], v245, s[64:67], s18 offen offset:1024 sc1
    buffer_load_dwordx4 v[8:11], v245, s[64:67], s18 offen offset:1792 sc1
    s_waitcnt vmcnt(3)
    v_mfma_f32_32x32x16_bf16 v[32:47], v[24:27], v[16:19], 0
    s_waitcnt vmcnt(2)
    v_mfma_f32_32x32x8_bf16 v[32:47], v[22:23], v[20:21], v[32:47]
    s_nop 7
    s_nop 3
    v_exp_f32 v32, v32
    v_exp_f32 v33, v33
    v_exp_f32 v34, v34
    v_exp_f32 v35, v35
    v_exp_f32 v36, v36
    v_exp_f32 v37, v37
    v_exp_f32 v38, v38
    v_exp_f32 v39, v39
    v_exp_f32 v40, v40
    v_exp_f32 v41, v41
    v_exp_f32 v42, v42
    v_exp_f32 v43, v43
    v_exp_f32 v44, v44
    v_exp_f32 v45, v45
    v_exp_f32 v46, v46
    v_exp_f32 v47, v47
    v_cvt_pk_bf16_f32 v32, v32, v33
    v_cvt_pk_bf16_f32 v33, v34, v35
    v_cvt_pk_bf16_f32 v34, v36, v37
    v_cvt_pk_bf16_f32 v35, v38, v39
    v_cvt_pk_bf16_f32 v36, v40, v41
    v_cvt_pk_bf16_f32 v37, v42, v43
    v_cvt_pk_bf16_f32 v38, v44, v45
    v_cvt_pk_bf16_f32 v39, v46, v47
    s_waitcnt vmcnt(1)
    v_mfma_f32_32x32x16_bf16 v[96:111], v[28:31], v[32:35], v[96:111]
    s_waitcnt vmcnt(0)
    v_mfma_f32_32x32x16_bf16 v[96:111], v[8:11], v[36:39], v[96:111]
    s_add_u32 s18, s18, 3072
    s_cmp_lt_u32 s18, 196608
    s_nop 7
    s_nop 1
    s_cbranch_scc1 t_fb2
    v_mov_b32 v242, v104
    v_mov_b32 v232, v104
    s_nop 1
    v_permlane32_swap_b32 v232, v242
    s_nop 4
    s_branch t_st0
f_end:
    s_endpgm

.section .rodata,"a"
.p2align 6
.amdhsa_kernel gated_mix__grouped_kv_mqa__spectral_fnet__prompt_kernel
  .amdhsa_next_free_vgpr 256
  .amdhsa_next_free_sgpr 102
  .amdhsa_accum_offset 256
  .amdhsa_group_segment_fixed_size 0
  .amdhsa_kernarg_size 112
  .amdhsa_user_sgpr_count 2
  .amdhsa_user_sgpr_kernarg_segment_ptr 1
  .amdhsa_system_sgpr_workgroup_id_x 1
.end_amdhsa_kernel
```
